```python
import torch

def _softmax(x, axis=-1):
    return torch.softmax(x, dim=axis)

def _gelu(x):
    return torch.nn.functional.gelu(x, approximate='tanh')

def _silu(x):
    return torch.nn.functional.silu(x)

def _sigmoid(x):
    return torch.sigmoid(x)

def _layernorm(x, axis=-1, eps=1e-05):
    m = x.mean(dim=axis, keepdim=True)
    v = x.var(dim=axis, keepdim=True, unbiased=False)
    return (x - m) / torch.sqrt(v + eps)

def _scatter_add(tgt, idx, src, axis=0):
    return tgt.clone().index_add_(axis, idx, src)

def _segment_sum(src, seg, n):
    out = torch.zeros((n,) + src.shape[1:], dtype=src.dtype)
    return out.index_add_(0, seg, src)

def _pad(x, pw):
    flat = tuple((v for pair in reversed(pw) for v in pair))
    return torch.nn.functional.pad(x, flat)
kernel_name = 'gather_scatter__tensor_product_equiv_mace__graph'

def setup_inputs():

    _w = lambda a: (lambda t: t.to(torch.bfloat16) if t.is_floating_point() else t)(torch.as_tensor(a))
    N, deg = (10000, 32)
    Lmax, C, De = (1, 128, 16)
    M = (Lmax + 1) ** 2
    E = N * deg
    src = (lambda lo, hi, *s: torch.randint(lo, hi, s))(0, N, E).to(torch.int64)
    dst = (lambda lo, hi, *s: torch.randint(lo, hi, s))(0, N, E).to(torch.int64)
    r = (lambda *s: torch.randn(*s, dtype=torch.bfloat16) * 0.05)(E, 3).to(float)
    r = r / (torch.linalg.norm(r, dim=-1, keepdim=True).to(float) + 1e-06)
    rx, ry, rz = (r[:, 0].clone(), r[:, 1].clone(), r[:, 2].clone())
    x2, y2, z2 = (rx * rx, ry * ry, rz * rz)
    sh_list = [torch.ones_like(rx), rx, ry, rz, rx * ry, ry * rz, 2.0 * z2 - x2 - y2, rx * rz, x2 - y2, ry * (3.0 * x2 - y2), rx * ry * rz, ry * (4.0 * z2 - x2 - y2), rz * (2.0 * z2 - 3.0 * x2 - 3.0 * y2), rx * (4.0 * z2 - x2 - y2), rz * (x2 - y2), rx * (x2 - 3.0 * y2)]
    sh16 = torch.stack(sh_list, dim=-1).to(float)
    pad = max(0, M - 16)
    sh_full = torch.cat([sh16, torch.zeros((E, pad), dtype=float)], dim=-1)[:, :M]
    cg = ((lambda *s: torch.randn(*s, dtype=torch.bfloat16) * 0.05)(M, M, M) * (1.0 / float(M))).to(float)
    return {'x': _w(((lambda *s: torch.randn(*s, dtype=torch.bfloat16) * 0.05)(N, M, C) * 0.3).to(float)), 'src': _w(src), 'dst': _w(dst), 'sh': _w(sh_full.to(float)), 'edge_attr': _w(((lambda *s: torch.randn(*s, dtype=torch.bfloat16) * 0.05)(E, De) * 0.3).to(float)), 'cg': _w(cg), 'w_r': _w(((lambda *s: torch.randn(*s, dtype=torch.bfloat16) * 0.05)(De, C) * (1.0 / float(De) ** 0.5)).to(float)), 'w_out': _w(((lambda *s: torch.randn(*s, dtype=torch.bfloat16) * 0.05)(C, C) * (1.0 / float(C) ** 0.5)).to(float))}

def reference(x, src, dst, sh, edge_attr, cg, w_r, w_out):
    N = x.shape[0]
    M = x.shape[1]
    C = x.shape[2]
    h = x[src]
    tp = torch.einsum('uvw,euc,ev->ewc', cg, h, sh)
    rw = edge_attr @ w_r
    msg = tp * rw[:, None, :]
    msg2 = msg.reshape(-1, M * C)
    agg = _segment_sum(msg2, dst, N).reshape(N, M, C)
    out = torch.einsum('nmc,cd->nmd', agg, w_out)
    return out
```

```asm
; @launch grid=(256,1,1) block=(512,1,1) lds=158784
.amdgcn_target "amdgcn-amd-amdhsa--gfx950"
.text
.globl gather_scatter__tensor_product_equiv_mace__graph_kernel
.p2align 8
.type gather_scatter__tensor_product_equiv_mace__graph_kernel,@function
gather_scatter__tensor_product_equiv_mace__graph_kernel:
    s_cmp_ge_u32 s2, 256
    s_cbranch_scc1 L_done
    s_load_dwordx4 s[4:7], s[0:1], 8
    s_load_dwordx4 s[8:11], s[0:1], 24
    s_load_dwordx2 s[14:15], s[0:1], 80
    s_load_dwordx2 s[64:65], s[0:1], 0
    s_load_dwordx2 s[66:67], s[0:1], 40
    s_load_dwordx4 s[68:71], s[0:1], 48
    s_load_dwordx2 s[12:13], s[0:1], 64
    v_lshlrev_b32 v10, 3, v0
    s_getpc_b64 s[80:81]
L_pc:
    s_and_b32 s44, s2, 0xf8
    s_lshl_b32 s44, s44, 6
    v_and_b32 v11, 0x180, v10
    v_add_u32 v11, s44, v11
    v_min_u32 v11, L_end-L_pc, v11
    v_mov_b32 v113, s81
    v_add_co_u32 v112, vcc, s80, v11
    s_nop 1
    v_addc_co_u32 v113, vcc, 0, v113, vcc
    global_load_dword v205, v[112:113], off
    v_lshrrev_b32 v8, 6, v0
    v_and_b32 v1, 63, v0
    v_lshlrev_b32 v9, 2, v0
    v_mov_b32 v13, 0
    v_readfirstlane_b32 s3, v8
    ds_write_b32 v9, v13 offset:23552
    ds_write_b32 v9, v13 offset:28672
    s_mul_i32 s54, s2, 5000
    s_mul_i32 s55, s2, 10000
    s_mul_i32 s61, s2, 40000
    v_lshlrev_b32 v2, 4, v1
    v_lshlrev_b32 v15, 4, v0
    v_mov_b32 v6, 1
    s_lshl_b32 s52, s3, 10
    s_add_u32 s52, s52, 101376
    s_movk_i32 s53, 4096
    s_movk_i32 s50, 8192
    s_mov_b32 s34, 5000
    s_mov_b32 s35, 0x20000
    s_mov_b32 s38, 5000
    s_mov_b32 s39, 0x20000
    s_mov_b32 s98, 10000
    s_mov_b32 s99, 0x20000
    s_mov_b32 s30, 40000
    s_mov_b32 s31, 0x20000
    s_waitcnt lgkmcnt(0)
    s_add_u32 s32, s6, s54
    s_addc_u32 s33, s7, 0
    buffer_load_dword v64, v9, s[32:35], 0 offen offset:0 nt
    buffer_load_dword v65, v9, s[32:35], 0 offen offset:2048 nt
    buffer_load_dword v66, v9, s[32:35], s53 offen nt
    s_add_u32 s36, s4, s54
    s_addc_u32 s37, s5, 0
    s_barrier
    buffer_load_dword v68, v9, s[36:39], 0 offen offset:0 nt
    buffer_load_dword v69, v9, s[36:39], 0 offen offset:2048 nt
    buffer_load_dword v70, v9, s[36:39], s53 offen nt
    s_load_dword s62, s[14:15], 524288
    s_add_u32 s96, s8, s55
    s_addc_u32 s97, s9, 0
    s_add_u32 s28, s10, s61
    s_addc_u32 s29, s11, 0
    buffer_load_dwordx2 v[72:73], v10, s[96:99], 0 offen nt
    buffer_load_dwordx2 v[74:75], v10, s[96:99], s53 offen nt
    buffer_load_dwordx2 v[76:77], v10, s[96:99], s50 offen nt
    s_add_u32 m0, s52, 0
    s_mov_b32 s54, 0
    buffer_load_dwordx4 v15, s[28:31], s54 offen nt lds
    s_add_u32 m0, s52, 8192
    s_mov_b32 s54, 8192
    buffer_load_dwordx4 v15, s[28:31], s54 offen nt lds
    s_add_u32 m0, s52, 16384
    s_mov_b32 s54, 16384
    buffer_load_dwordx4 v15, s[28:31], s54 offen nt lds
    s_mov_b32 s72, 109951168
    s_movk_i32 s73, 625
    s_movk_i32 s74, 838
    s_movk_i32 s54, 226
    v_cmp_gt_u32 s[84:85], s54, v0
    s_mov_b32 s20, s14
    s_mov_b32 s21, s15
    s_mov_b32 s22, 524352
    s_mov_b32 s23, 0x20000
    v_lshlrev_b32 v11, 2, v0
    v_mov_b32 v12, 0x00700000
    v_mov_b32 v13, 0
    ds_write_b32 v11, v12 offset:0
    ds_write_b32 v11, v12 offset:2048
    ds_write_b32 v11, v12 offset:4096
    ds_write_b32 v11, v12 offset:6144
    ds_write_b32 v11, v13 offset:8192
    ds_write_b32 v11, v13 offset:10240
    ds_write_b32 v11, v13 offset:12288
    ds_write_b32 v11, v13 offset:14336
    s_waitcnt vmcnt(9)
    v_mul_hi_u32 v80, v64, s72
    v_mul_hi_u32 v81, v65, s72
    v_mul_hi_u32 v82, v66, s72
    v_lshlrev_b32 v84, 2, v80
    ds_add_rtn_u32 v88, v84, v6 offset:23552
    v_lshlrev_b32 v85, 2, v81
    ds_add_rtn_u32 v89, v85, v6 offset:23552
    v_lshlrev_b32 v86, 2, v82
    s_mov_b64 exec, s[84:85]
    ds_add_rtn_u32 v90, v86, v6 offset:23552
    s_mov_b64 exec, -1
    s_waitcnt lgkmcnt(0)
    s_barrier
    ds_read_b128 v[100:103], v2 offset:23552
    s_mul_i32 s62, s62, 0x9e3779b1
    s_add_u32 s62, s62, 0x7f4a7c15
    s_mul_i32 s63, s62, 0x85ebca6b
    s_and_b32 s63, s63, 0xffc00000
    s_add_u32 m0, s52, 24576
    s_mov_b32 s54, 24576
    buffer_load_dwordx4 v15, s[28:31], s54 offen nt lds
    s_add_u32 m0, s52, 32768
    s_mov_b32 s54, 32768
    buffer_load_dwordx4 v15, s[28:31], s54 offen nt lds
    v_mad_u32_u24 v92, v80, s73, 15
    v_lshrrev_b32 v92, 4, v92
    v_sub_u32 v92, v64, v92
    v_mad_u32_u24 v93, v81, s73, 15
    v_lshrrev_b32 v93, 4, v93
    v_sub_u32 v93, v65, v93
    v_mad_u32_u24 v94, v82, s73, 15
    v_lshrrev_b32 v94, 4, v94
    v_sub_u32 v94, v66, v94
    s_waitcnt lgkmcnt(0)
    v_add_u32 v11, v100, v101
    v_add3_u32 v11, v11, v102, v103
    v_mov_b32 v12, v11
    s_nop 1
    v_add_u32_dpp v12, v12, v12 row_shr:1 row_mask:0xf bank_mask:0xf
    s_nop 1
    v_add_u32_dpp v12, v12, v12 row_shr:2 row_mask:0xf bank_mask:0xf
    s_nop 1
    v_add_u32_dpp v12, v12, v12 row_shr:4 row_mask:0xf bank_mask:0xf
    s_nop 1
    v_add_u32_dpp v12, v12, v12 row_shr:8 row_mask:0xf bank_mask:0xf
    s_nop 1
    v_add_u32_dpp v12, v12, v12 row_bcast:15 row_mask:0xa bank_mask:0xf
    s_nop 1
    v_add_u32_dpp v12, v12, v12 row_bcast:31 row_mask:0xc bank_mask:0xf
    v_sub_u32 v104, v12, v11
    v_add_u32 v105, v104, v100
    v_add_u32 v106, v105, v101
    v_add_u32 v107, v106, v102
    ds_write_b128 v2, v[104:107] offset:24576
    ds_read_b32 v108, v84 offset:24576
    ds_read_b32 v109, v85 offset:24576
    ds_read_b32 v110, v86 offset:24576
    s_waitcnt vmcnt(8)
    v_mul_u32_u24 v96, s74, v68
    v_bfe_u32 v96, v96, 18, 5
    v_lshl_or_b32 v96, v92, 5, v96
    v_lshlrev_b32 v96, 21, v96
    v_lshl_or_b32 v96, v68, 7, v96
    v_mul_u32_u24 v97, s74, v69
    v_bfe_u32 v97, v97, 18, 5
    v_lshl_or_b32 v97, v93, 5, v97
    v_lshlrev_b32 v97, 21, v97
    v_lshl_or_b32 v97, v69, 7, v97
    v_mul_u32_u24 v98, s74, v70
    v_bfe_u32 v98, v98, 18, 5
    v_lshl_or_b32 v98, v94, 5, v98
    v_lshlrev_b32 v98, 21, v98
    v_lshl_or_b32 v98, v70, 7, v98
    v_lshlrev_b32 v92, 5, v0
    v_add_u32 v93, 16384, v92
    v_add_u32 v94, 32768, v92
    s_mov_b32 s55, 30720
    s_waitcnt vmcnt(5) lgkmcnt(0)
    v_add_u32 v108, v108, v88
    v_lshlrev_b32 v84, 2, v108
    v_mad_u32_u24 v108, v108, 12, s55
    ds_write_b32 v84, v92 offset:25600
    ds_write2_b32 v108, v72, v73 offset0:0 offset1:1
    ds_write_b32 v108, v96 offset:8
    v_add_u32 v109, v109, v89
    v_lshlrev_b32 v85, 2, v109
    v_mad_u32_u24 v109, v109, 12, s55
    ds_write_b32 v85, v93 offset:25600
    ds_write2_b32 v109, v74, v75 offset0:0 offset1:1
    ds_write_b32 v109, v97 offset:8
    v_add_u32 v110, v110, v90
    v_lshlrev_b32 v86, 2, v110
    v_mad_u32_u24 v110, v110, 12, s55
    s_mov_b64 exec, s[84:85]
    ds_write_b32 v86, v94 offset:25600
    ds_write2_b32 v110, v76, v77 offset0:0 offset1:1
    ds_write_b32 v110, v98 offset:8
    s_mov_b64 exec, -1
    s_lshl_b32 s54, s3, 7
    v_lshl_add_u32 v11, v1, 3, s54
    ds_read_b64 v[100:101], v11 offset:23552
    ds_read_b64 v[104:105], v11 offset:24576
    s_mul_i32 s54, s2, 15360
    s_add_u32 s54, s54, 1048576
    s_add_u32 s32, s14, s54
    s_addc_u32 s33, s15, 0
    s_mov_b32 s34, 15360
    s_mov_b32 s35, 0x20000
    s_mul_i32 s54, s2, 40960
    s_add_u32 s54, s54, 5242880
    s_add_u32 s36, s14, s54
    s_addc_u32 s37, s15, 0
    s_mov_b32 s38, 40064
    s_mov_b32 s39, 0x20000
    v_lshrrev_b32 v11, 1, v0
    v_lshlrev_b32 v11, 2, v11
    v_and_b32 v12, 1, v0
    v_lshlrev_b32 v12, 4, v12
    v_add_u32 v12, 101376, v12
    v_add_u32 v14, 30720, v15
    s_waitcnt lgkmcnt(0)
    s_barrier
    ds_read_b128 v[128:131], v14
    ds_read_b128 v[132:135], v14 offset:8192
    ds_read_b32 v156, v11 offset:25600
    ds_read_b32 v157, v11 offset:26624
    ds_read_b32 v158, v11 offset:27648
    ds_read_b32 v159, v11 offset:28672
    ds_read_b32 v160, v11 offset:29696
    s_cmp_lt_u32 s3, 4
    s_cselect_b32 s16, s68, s66
    s_cselect_b32 s17, s69, s67
    s_movk_i32 s54, 128
    s_cselect_b32 s18, s53, s54
    s_mov_b32 s19, 0x20000
    s_min_u32 s54, s3, 5
    s_lshl_b32 s54, s54, 10
    s_add_u32 m0, s54, 17408
    s_and_b32 s54, s54, 0xc00
    buffer_load_dwordx4 v2, s[16:19], s54 offen lds
    s_mov_b32 s40, s70
    s_mov_b32 s41, s71
    s_mov_b32 s42, 32768
    s_mov_b32 s43, 0x20000
    s_lshl_b32 s55, s3, 12
    s_add_u32 m0, s55, 46080
    s_nop 0
    buffer_load_dwordx4 v2, s[40:43], s55 offen offset:0 lds
    buffer_load_dwordx4 v2, s[40:43], s55 offen offset:1024 lds
    buffer_load_dwordx4 v2, s[40:43], s55 offen offset:2048 lds
    buffer_load_dwordx4 v2, s[40:43], s55 offen offset:3072 lds
    s_waitcnt lgkmcnt(0)
    v_add_u32 v156, v12, v156
    v_add_u32 v157, v12, v157
    v_add_u32 v158, v12, v158
    v_add_u32 v159, v12, v159
    v_add_u32 v160, v12, v160
    v_lshl_or_b32 v112, v100, 11, v104
    v_or_b32 v112, s63, v112
    v_mov_b32 v113, s62
    v_lshl_or_b32 v114, v101, 11, v105
    v_or_b32 v114, s63, v114
    v_mov_b32 v115, s62
    s_waitcnt vmcnt(0)
    s_barrier
    ds_read_b128 v[136:139], v156
    ds_read_b128 v[140:143], v157
    ds_read_b128 v[144:147], v158
    ds_read_b128 v[148:151], v159
    ds_read_b128 v[152:155], v160
    buffer_store_dwordx4 v[128:131], v15, s[32:35], 0 offen sc1
    buffer_store_dwordx4 v[132:135], v15, s[32:35], s50 offen sc1
    s_mov_b32 s54, 0
    s_waitcnt lgkmcnt(4)
    buffer_store_dwordx4 v[136:139], v15, s[36:39], s54 offen sc1
    s_mov_b32 s54, 8192
    s_waitcnt lgkmcnt(3)
    buffer_store_dwordx4 v[140:143], v15, s[36:39], s54 offen sc1
    s_mov_b32 s54, 16384
    s_waitcnt lgkmcnt(2)
    buffer_store_dwordx4 v[144:147], v15, s[36:39], s54 offen sc1
    s_mov_b32 s54, 24576
    s_waitcnt lgkmcnt(1)
    buffer_store_dwordx4 v[148:151], v15, s[36:39], s54 offen sc1
    s_mov_b32 s54, 32768
    s_waitcnt lgkmcnt(0)
    buffer_store_dwordx4 v[152:155], v15, s[36:39], s54 offen sc1
    s_and_b32 s44, s2, 7
    s_lshl_b32 s44, s44, 5
    s_lshr_b32 s54, s2, 3
    s_add_u32 s44, s44, s54
    s_mul_i32 s45, s44, 625
    s_add_u32 s46, s45, 640
    s_add_u32 s45, s45, 15
    s_lshr_b32 s45, s45, 4
    s_lshr_b32 s46, s46, 4
    s_sub_u32 s46, s46, s45
    v_bfe_i32 v168, v1, 2, 1
    v_and_b32 v168, 0xaaaa, v168
    v_add_u32 v168, 0x4444, v168
    v_mov_b32 v169, 158720
    v_and_b32 v11, 60, v9
    v_add_u32 v11, v11, v169
    ds_write_b32 v11, v13
    v_and_b32 v11, 4, v1
    v_lshlrev_b32 v11, 2, v11
    v_mov_b32 v12, 0xffff
    v_lshlrev_b32 v12, v11, v12
    v_bfe_i32 v11, v1, 3, 1
    v_and_b32 v191, v11, v12
    v_xor_b32 v190, v191, v12
    v_mov_b32 v11, 0x0c0c0c0c
    v_mov_b32 v12, 0x03020302
    v_bfi_b32 v254, v190, v12, v11
    v_bfi_b32 v255, v191, v12, v11
    v_mov_b32 v12, 0x01000100
    v_bfi_b32 v190, v190, v12, v11
    v_bfi_b32 v191, v191, v12, v11
    v_lshrrev_b32 v200, 5, v1
    v_lshlrev_b32 v200, 4, v200
    v_add_u32 v200, 101376, v200
    v_and_b32 v201, 15, v1
    v_lshlrev_b32 v201, 2, v201
    v_bfe_u32 v11, v1, 3, 2
    v_and_b32 v12, 3, v1
    v_lshl_add_u32 v11, v11, 2, v12
    v_lshlrev_b32 v202, 2, v11
    v_bfe_i32 v240, v0, 0, 1
    s_lshl_b32 s54, s3, 10
    v_and_b32 v241, 4, v240
    v_add_u32 v241, s54, v241
    v_lshl_add_u32 v242, v1, 2, s54
    v_lshrrev_b32 v243, 1, v1
    v_lshl_add_u32 v243, v243, 2, s54
    v_mul_u32_u24 v244, 12, v1
    v_and_b32 v245, 12, v242
    v_and_b32 v250, 124, v242
    s_mul_i32 s54, s3, 224
    v_add_u32 v247, s54, v1
    v_lshlrev_b32 v246, 3, v247
    v_add_u32 v246, 87040, v246
    v_lshlrev_b32 v247, 21, v247
    s_mul_i32 s54, s3, 640
    v_add_u32 v248, s54, v250
    v_sub_u32 v249, 63, v1
    s_getreg_b32 s86, hwreg(HW_REG_XCC_ID, 0, 3)
    s_lshl_b32 s54, s86, 4
    v_subrev_u32 v250, s54, v250
    v_and_b32 v250, 124, v250
    v_min_u32 v251, 39, v1
    v_lshlrev_b32 v251, 7, v251
    v_mov_b32 v253, 0x380
    v_lshrrev_b32 v252, 3, v1
    v_mul_u32_u24 v252, 64, v252
    v_add_u32 v252, 78848, v252
    s_lshr_b32 s87, s3, 1
    s_mul_i32 s87, s87, 3
    s_min_u32 s87, s87, 8
    s_mul_i32 s54, s87, 4608
    v_and_b32 v11, 15, v1
    v_lshrrev_b32 v12, 4, v1
    v_mul_u32_u24 v213, 288, v11
    v_lshl_add_u32 v213, v12, 4, v213
    v_add_u32 v213, s54, v213
    v_lshrrev_b32 v12, 3, v1
    v_lshlrev_b32 v12, 9, v12
    v_and_b32 v11, 7, v1
    v_lshl_add_u32 v214, v11, 4, v12
    s_lshl_b32 s87, s87, 12
    s_and_b32 s54, s3, 1
    s_lshl_b32 s54, s54, 7
    s_add_u32 s87, s87, s54
    s_lshl_b32 s54, s54, 7
    s_add_u32 s54, s54, 46080
    v_add_u32 v215, s54, v2
    s_cmp_eq_u32 s46, 40
    v_mov_b32 v203, 0
    s_mov_b32 s54, 685900808
    s_cselect_b32 s54, 568459824, s54
    s_mov_b32 exec_lo, 31
    s_mov_b32 exec_hi, 0
    v_mov_b32 v203, s54
    s_mov_b32 s54, 182814793
    s_cselect_b32 s54, 23232528, s54
    s_mov_b32 exec_lo, 992
    s_mov_b32 exec_hi, 0
    v_mov_b32 v203, s54
    s_mov_b32 s54, 984091248
    s_cselect_b32 s54, 719688297, s54
    s_mov_b32 exec_lo, 31744
    s_mov_b32 exec_hi, 0
    v_mov_b32 v203, s54
    s_mov_b32 s54, 424091761
    s_cselect_b32 s54, 984423522, s54
    s_mov_b32 exec_lo, 1015808
    s_mov_b32 exec_hi, 0
    v_mov_b32 v203, s54
    s_mov_b32 s54, 586001611
    s_cselect_b32 s54, 172635826, s54
    s_mov_b32 exec_lo, 32505856
    s_mov_b32 exec_hi, 0
    v_mov_b32 v203, s54
    s_mov_b32 s54, 64039106
    s_cselect_b32 s54, 454017211, s54
    s_mov_b32 exec_lo, 1040187392
    s_mov_b32 exec_hi, 0
    v_mov_b32 v203, s54
    s_mov_b32 s54, 330320603
    s_cselect_b32 s54, 743654643, s54
    s_mov_b32 exec_lo, 3221225472
    s_mov_b32 exec_hi, 7
    v_mov_b32 v203, s54
    s_mov_b32 s54, 217139484
    s_cselect_b32 s54, 607143691, s54
    s_mov_b32 exec_lo, 0
    s_mov_b32 exec_hi, 248
    v_mov_b32 v203, s54
    s_mov_b64 exec, -1
    v_mul_u32_u24 v11, 52, v1
    v_lshrrev_b32 v11, 8, v11
    v_mad_i32_i24 v11, v11, -5, v1
    v_mul_u32_u24 v11, 6, v11
    v_lshrrev_b32 v203, v11, v203
    v_and_b32 v11, 7, v203
    v_bfe_u32 v203, v203, 3, 3
    v_lshlrev_b32 v11, 12, v11
    v_lshl_or_b32 v203, v203, 7, v11
    s_add_u32 s24, s14, 1048576
    s_addc_u32 s25, s15, 0
    s_mov_b32 s26, 3932160
    s_mov_b32 s27, 0x20000
    v_mov_b32 v16, 0
    v_mov_b32 v17, 0
    v_mov_b32 v18, 0
    v_mov_b32 v19, 0
    v_mov_b32 v20, 0
    v_mov_b32 v21, 0
    v_mov_b32 v22, 0
    v_mov_b32 v23, 0
    v_mov_b32 v24, 0
    v_mov_b32 v25, 0
    v_mov_b32 v26, 0
    v_mov_b32 v27, 0
    v_mov_b32 v28, 0
    v_mov_b32 v29, 0
    v_mov_b32 v30, 0
    v_mov_b32 v31, 0
    v_mov_b32 v32, 0
    v_mov_b32 v33, 0
    v_mov_b32 v34, 0
    v_mov_b32 v35, 0
    v_mov_b32 v36, 0
    v_mov_b32 v37, 0
    v_mov_b32 v38, 0
    v_mov_b32 v39, 0
    v_mov_b32 v40, 0
    v_mov_b32 v41, 0
    v_mov_b32 v42, 0
    v_mov_b32 v43, 0
    v_mov_b32 v44, 0
    v_mov_b32 v45, 0
    v_mov_b32 v46, 0
    v_mov_b32 v47, 0
    v_mov_b32 v48, 0
    v_mov_b32 v49, 0
    v_mov_b32 v50, 0
    v_mov_b32 v51, 0
    v_mov_b32 v52, 0
    v_mov_b32 v53, 0
    v_mov_b32 v54, 0
    v_mov_b32 v55, 0
    v_mov_b32 v56, 0
    v_mov_b32 v57, 0
    v_mov_b32 v58, 0
    v_mov_b32 v59, 0
    v_mov_b32 v60, 0
    v_mov_b32 v61, 0
    v_mov_b32 v62, 0
    v_mov_b32 v63, 0
    s_lshl_b32 s54, s2, 3
    s_add_u32 s54, s54, s3
    s_lshl_b32 s54, s54, 8
    s_mov_b32 s16, s64
    s_mov_b32 s17, s65
    s_mov_b32 s18, 10240000
    s_mov_b32 s19, 0x20000
    s_add_u32 s28, s14, 5242880
    s_addc_u32 s29, s15, 0
    s_mov_b32 s30, 10485760
    s_mov_b32 s31, 0x20000
    s_and_b32 s51, s86, 7
    s_mul_i32 s51, s51, 1282048
    s_and_b32 s55, s2, 0xf8
    s_add_u32 s55, s55, s3
    s_mul_i32 s55, s55, 2304
    s_add_u32 s51, s51, s55
    v_min_u32 v7, 17, v1
    v_lshlrev_b32 v7, 7, v7
    s_waitcnt vmcnt(0)
    s_barrier
    s_mov_b64 exec, 0xffff
    buffer_store_dwordx4 v[112:115], v2, s[20:23], s54 offen sc1
    s_mov_b64 exec, -1
    buffer_load_dword v7, v7, s[16:19], s51 offen
    s_lshl_b32 s54, s45, 10
    s_add_u32 s40, s12, s54
    s_addc_u32 s41, s13, 0
    s_lshl_b32 s42, s46, 10
    s_mov_b32 s43, 0x20000
    v_lshrrev_b32 v8, 5, v1
    v_lshlrev_b32 v8, 10, v8
    v_and_b32 v9, 15, v1
    v_lshl_add_u32 v8, v9, 4, v8
    ds_read_b128 v[64:67], v8 offset:17408
    ds_read_b128 v[68:71], v8 offset:17664
    ds_read_b128 v[72:75], v8 offset:17920
    ds_read_b128 v[76:79], v8 offset:18176
    ds_read_b128 v[80:83], v8 offset:19456
    ds_read_b128 v[84:87], v8 offset:19712
    ds_read_b128 v[88:91], v8 offset:19968
    ds_read_b128 v[92:95], v8 offset:20224
    v_lshrrev_b32 v8, 4, v1
    v_lshlrev_b32 v8, 5, v8
    v_and_b32 v9, 3, v1
    v_lshl_add_u32 v8, v9, 1, v8
    ds_read_u16 v96, v8 offset:21504
    ds_read_u16 v97, v8 offset:21512
    ds_read_u16 v98, v8 offset:21520
    ds_read_u16 v99, v8 offset:21528
    v_bfe_i32 v10, v1, 4, 1
    v_and_b32 v10, 0x02020202, v10
    v_add_u32 v10, 0x05040100, v10
    s_waitcnt lgkmcnt(0)
    v_perm_b32 v172, v68, v64, v10
    v_perm_b32 v174, v76, v72, v10
    v_perm_b32 v176, v84, v80, v10
    v_perm_b32 v178, v92, v88, v10
    v_perm_b32 v173, v69, v65, v10
    v_perm_b32 v175, v77, v73, v10
    v_perm_b32 v177, v85, v81, v10
    v_perm_b32 v179, v93, v89, v10
    v_perm_b32 v180, v70, v66, v10
    v_perm_b32 v182, v78, v74, v10
    v_perm_b32 v184, v86, v82, v10
    v_perm_b32 v186, v94, v90, v10
    v_perm_b32 v181, v71, v67, v10
    v_perm_b32 v183, v79, v75, v10
    v_perm_b32 v185, v87, v83, v10
    v_perm_b32 v187, v95, v91, v10
    v_lshl_or_b32 v188, v97, 16, v96
    v_lshl_or_b32 v189, v99, 16, v98
    v_and_b32 v9, 7, v1
    v_lshrrev_b32 v8, 4, v1
    v_lshlrev_b32 v8, 13, v8
    v_lshl_add_u32 v8, v9, 4, v8
    v_and_b32 v9, 8, v1
    s_and_b32 s72, s3, 3
    s_lshl_b32 s72, s72, 8
    s_lshr_b32 s73, s3, 2
    s_lshl_b32 s73, s73, 7
    s_add_u32 s72, s72, s73
    s_add_u32 s72, s72, 46080
    v_add3_u32 v8, v8, v9, s72
    ds_read2st64_b64 v[128:131], v8 offset0:0 offset1:2
    ds_read2st64_b64 v[132:135], v8 offset0:4 offset1:6
    ds_read2st64_b64 v[136:139], v8 offset0:8 offset1:10
    ds_read2st64_b64 v[140:143], v8 offset0:12 offset1:14
    s_mov_b32 s72, 0x05040100
    s_mov_b32 s73, 0x07060302
    s_waitcnt lgkmcnt(3)
    v_perm_b32 v144, v130, v128, s72
    v_perm_b32 v148, v130, v128, s73
    v_perm_b32 v152, v131, v129, s72
    v_perm_b32 v156, v131, v129, s73
    s_waitcnt lgkmcnt(2)
    v_perm_b32 v145, v134, v132, s72
    v_perm_b32 v149, v134, v132, s73
    v_perm_b32 v153, v135, v133, s72
    v_perm_b32 v157, v135, v133, s73
    s_waitcnt lgkmcnt(1)
    v_perm_b32 v146, v138, v136, s72
    v_perm_b32 v150, v138, v136, s73
    v_perm_b32 v154, v139, v137, s72
    v_perm_b32 v158, v139, v137, s73
    s_waitcnt lgkmcnt(0)
    v_perm_b32 v147, v142, v140, s72
    v_perm_b32 v151, v142, v140, s73
    v_perm_b32 v155, v143, v141, s72
    v_perm_b32 v159, v143, v141, s73
    v_mov_b32 v64, 0
    v_mov_b32 v65, 0
    v_mov_b32 v66, 0
    v_mov_b32 v67, 0
    v_mov_b32 v68, 0
    v_mov_b32 v69, 0
    v_mov_b32 v70, 0
    v_mov_b32 v71, 0
    v_mov_b32 v72, 0
    v_mov_b32 v73, 0
    v_mov_b32 v74, 0
    v_mov_b32 v75, 0
    v_mov_b32 v76, 0
    v_mov_b32 v77, 0
    v_mov_b32 v78, 0
    v_mov_b32 v79, 0
    v_mov_b32 v80, 0
    v_mov_b32 v81, 0
    v_mov_b32 v82, 0
    v_mov_b32 v83, 0
    v_mov_b32 v84, 0
    v_mov_b32 v85, 0
    v_mov_b32 v86, 0
    v_mov_b32 v87, 0
    v_mov_b32 v88, 0
    v_mov_b32 v89, 0
    v_mov_b32 v90, 0
    v_mov_b32 v91, 0
    v_mov_b32 v92, 0
    v_mov_b32 v93, 0
    v_mov_b32 v94, 0
    v_mov_b32 v95, 0
    s_lshl_b32 s54, s3, 12
    v_add_u32 v8, s54, v2
    v_lshrrev_b32 v9, 1, v0
    v_lshlrev_b32 v10, 11, v9
    s_lshl_b32 s49, s44, 3
    v_mul_u32_u24 v5, 1280, v9
    s_mov_b32 s48, 0
    s_mov_b32 s53, 200000
    s_mov_b32 s55, 0xffc00000
    s_mul_i32 s52, s3, 7168
    s_add_u32 s52, s52, 101376
    s_movk_i32 s98, 4096
    s_waitcnt vmcnt(0)
    s_barrier
    buffer_load_dwordx2 v[206:207], v10, s[20:23], s49 offen sc1
    ds_write_b128 v8, v[144:147] offset:46080
    ds_write_b128 v8, v[148:151] offset:47104
    ds_write_b128 v8, v[152:155] offset:48128
    ds_write_b128 v8, v[156:159] offset:49152
    s_waitcnt vmcnt(0)
    v_xor_b32 v11, s63, v206
    v_xor_b32 v12, s62, v207
    v_and_or_b32 v11, v11, s55, v12
    v_cmpx_ne_u32 vcc, 0, v11
    s_cbranch_execnz L_poll
L_polled:
    s_mov_b64 exec, -1
    v_bfe_u32 v3, v206, 11, 11
    v_and_b32 v4, v3, v240
    v_add_u32 v10, v3, v240
    v_and_b32 v11, 0x7ff, v206
    v_add_u32_dpp v4, v4, v4 row_shr:1 row_mask:0xf bank_mask:0xf
    v_cmp_lt_i32 s[64:65], 0, v10
    v_cmp_lt_i32 s[66:67], 2, v10
    v_add_u32_dpp v4, v4, v4 row_shr:2 row_mask:0xf bank_mask:0xf
    v_cmp_lt_i32 s[68:69], 4, v10
    v_cmp_lt_i32 s[70:71], 6, v10
    v_add_u32_dpp v4, v4, v4 row_shr:4 row_mask:0xf bank_mask:0xf
    v_cmp_lt_i32 s[72:73], 8, v10
    v_cmp_lt_i32 s[74:75], 10, v10
    v_add_u32_dpp v4, v4, v4 row_shr:8 row_mask:0xf bank_mask:0xf
    v_cmp_lt_i32 s[76:77], 12, v10
    v_cmp_lt_i32 s[78:79], 14, v10
    v_add_u32_dpp v4, v4, v4 row_bcast:15 row_mask:0xa bank_mask:0xf
    v_add_u32 v5, v5, v11
    s_nop 0
    v_add_u32_dpp v4, v4, v4 row_bcast:31 row_mask:0xc bank_mask:0xf
    s_nop 0
    v_readlane_b32 s95, v4, 63
    v_mov_b32_dpp v4, v4 quad_perm:[0,0,2,2] row_mask:0xf bank_mask:0xf
    v_sub_u32 v5, v5, v4
    v_lshl_add_u32 v8, v4, 2, v241
    s_cmp_gt_u32 s95, 224
    s_cbranch_scc1 L_clip
L_mapw:
    s_mov_b64 exec, s[64:65]
    ds_write_b32 v8, v5 offset:0
    s_mov_b64 exec, s[66:67]
    ds_write_b32 v8, v5 offset:8
    s_mov_b64 exec, s[68:69]
    ds_write_b32 v8, v5 offset:16
    s_mov_b64 exec, s[70:71]
    ds_write_b32 v8, v5 offset:24
    s_mov_b64 exec, s[72:73]
    ds_write_b32 v8, v5 offset:32
    s_mov_b64 exec, s[74:75]
    ds_write_b32 v8, v5 offset:40
    s_mov_b64 exec, s[76:77]
    ds_write_b32 v8, v5 offset:48
    s_mov_b64 exec, -1
    s_cmp_lg_u64 s[78:79], 0
    s_cbranch_scc1 L_map2
    ds_read_b32 v136, v242 offset:0
    ds_read_b32 v137, v242 offset:256
    ds_read_b32 v138, v242 offset:512
    ds_read_b32 v140, v243 offset:0
    ds_read_b32 v141, v243 offset:128
    ds_read_b32 v142, v243 offset:256
    ds_read_b32 v143, v243 offset:384
    ds_read_b32 v144, v243 offset:512
    ds_read_b32 v145, v243 offset:640
    s_cmp_gt_i32 s95, 192
    s_cbranch_scc1 L_r1
L_r1b:
    s_waitcnt lgkmcnt(6)
    v_mad_u32_u24 v136, v136, 12, v244
    buffer_load_dwordx3 v[148:150], v136, s[24:27], 0 offen offset:0 sc1
    v_mad_u32_u24 v137, v137, 12, v244
    buffer_load_dwordx3 v[152:154], v137, s[24:27], 0 offen offset:768 sc1
    v_mad_u32_u24 v138, v138, 12, v244
    buffer_load_dwordx3 v[156:158], v138, s[24:27], 0 offen offset:1536 sc1
    v_mov_b32 v11, s95
    s_mov_b64 exec, 1
    ds_max_i32 v13, v11 offset:15360
    s_mov_b64 exec, -1
    s_waitcnt lgkmcnt(1)
    v_lshl_add_u32 v140, v140, 5, v2
    v_lshl_add_u32 v141, v141, 5, v2
    v_lshl_add_u32 v142, v142, 5, v2
    v_lshl_add_u32 v143, v143, 5, v2
    v_lshl_add_u32 v144, v144, 5, v2
    v_lshl_add_u32 v145, v145, 5, v2
    s_barrier
    s_add_u32 m0, s52, 0
    s_nop 0
    buffer_load_dwordx4 v140, s[28:31], 0 offen offset:0 sc1 lds
    buffer_load_dwordx4 v141, s[28:31], 0 offen offset:1024 sc1 lds
    s_min_i32 s54, s95, 224
    v_cmp_gt_i32 s[80:81], s54, v1
    s_sub_i32 s54, s54, 64
    v_cmp_gt_i32 s[82:83], s54, v1
    s_sub_i32 s54, s54, 64
    v_cmp_gt_i32 s[84:85], s54, v1
    s_sub_i32 s54, s54, 64
    v_cmp_gt_i32 s[96:97], s54, v1
    s_sub_i32 s54, s54, 64
    s_mov_b32 s55, 0x1fff80
    s_mul_i32 s61, s3, 5
    ds_read_b128 v[216:219], v215 offset:0
    ds_read_b128 v[220:223], v215 offset:1024
    ds_read_b128 v[224:227], v215 offset:2048
    ds_read_b128 v[228:231], v215 offset:3072
    ds_read_b128 v[232:235], v215 offset:4096
    ds_read_b128 v[236:239], v215 offset:5120
    s_waitcnt vmcnt(4)
    v_lshrrev_b32 v132, 21, v150
    v_lshlrev_b32 v132, 2, v132
    v_lshrrev_b32 v11, 26, v150
    v_lshl_or_b32 v11, v11, 4, v245
    s_mov_b64 exec, s[80:81]
    ds_add_rtn_u32 v128, v132, v6 offset:8192
    ds_add_u32 v11, v6 offset:14336
    s_mov_b64 exec, -1
    s_waitcnt vmcnt(3)
    v_lshrrev_b32 v133, 21, v154
    v_lshlrev_b32 v133, 2, v133
    v_lshrrev_b32 v11, 26, v154
    v_lshl_or_b32 v11, v11, 4, v245
    s_mov_b64 exec, s[82:83]
    ds_add_rtn_u32 v129, v133, v6 offset:8192
    ds_add_u32 v11, v6 offset:14336
    s_mov_b64 exec, -1
    s_waitcnt vmcnt(2)
    v_lshrrev_b32 v134, 21, v158
    v_lshlrev_b32 v134, 2, v134
    v_lshrrev_b32 v11, 26, v158
    v_lshl_or_b32 v11, v11, 4, v245
    s_mov_b64 exec, s[84:85]
    ds_add_rtn_u32 v130, v134, v6 offset:8192
    ds_add_u32 v11, v6 offset:14336
    s_mov_b64 exec, -1
    s_cmp_gt_i32 s95, 192
    s_cbranch_scc1 L_r2
L_r2b:
    s_or_b32 s54, s2, s3
    s_cbranch_scc0 L_tag
L_tagged:
    buffer_load_dwordx4 v142, s[28:31], 0 offen offset:2048 sc1 lds
    s_add_u32 s65, s61, 1
    s_add_u32 s66, s61, 2
    s_add_u32 s67, s61, 3
    s_add_u32 s68, s61, 4
    s_waitcnt lgkmcnt(0)
    s_barrier
    s_cmp_lg_u32 s48, 0
    s_cbranch_scc1 L_rank2
    ds_read_b128 v[104:107], v2 offset:14336
    ds_read_b32 v96, v248 offset:8192
    ds_read_b32 v97, v248 offset:8320
    ds_read_b32 v98, v248 offset:8448
    ds_read_b32 v99, v248 offset:8576
    ds_read_b32 v100, v248 offset:8704
    ds_read_b32 v14, v13 offset:15360
    ds_write_b64 v246, v[148:149] offset:0
    v_and_or_b32 v150, v150, s55, v247
    ds_write_b64 v246, v[152:153] offset:512
    v_and_or_b32 v154, v154, s55, v247
    v_add_u32 v154, 134217728, v154
    ds_write_b64 v246, v[156:157] offset:1024
    v_and_or_b32 v158, v158, s55, v247
    v_add_u32 v158, 268435456, v158
    s_waitcnt lgkmcnt(9)
    v_add_u32 v9, v104, v105
    v_add3_u32 v9, v9, v106, v107
    v_lshl_or_b32 v9, v9, 6, v249
    s_nop 0
    v_readlane_b32 s64, v9, s61
    v_readlane_b32 s65, v9, s65
    v_readlane_b32 s66, v9, s66
    v_readlane_b32 s67, v9, s67
    v_readlane_b32 s68, v9, s68
    v_cmp_lt_u32 s[70:71], s64, v9
    v_cmp_lt_u32 s[72:73], s65, v9
    v_cmp_lt_u32 s[74:75], s66, v9
    v_cmp_lt_u32 s[76:77], s67, v9
    v_cmp_lt_u32 s[78:79], s68, v9
    s_bcnt1_i32_b64 s64, s[70:71]
    s_bcnt1_i32_b64 s65, s[72:73]
    s_bcnt1_i32_b64 s66, s[74:75]
    s_bcnt1_i32_b64 s67, s[76:77]
    s_bcnt1_i32_b64 s68, s[78:79]
    s_waitcnt lgkmcnt(3)
    v_readlane_b32 s90, v203, s64
    v_readlane_b32 s91, v203, s65
    v_readlane_b32 s92, v203, s66
    v_readlane_b32 s93, v203, s67
    v_readlane_b32 s94, v203, s68
    v_readfirstlane_b32 s47, v14
L_ranked:
    s_mov_b32 exec_hi, 0
    v_and_or_b32 v104, s90, v253, v250
    ds_add_rtn_u32 v96, v104, v96 offset:13312
    v_and_or_b32 v105, s91, v253, v250
    ds_add_rtn_u32 v97, v105, v97 offset:13312
    v_and_or_b32 v106, s92, v253, v250
    ds_add_rtn_u32 v98, v106, v98 offset:13312
    v_and_or_b32 v107, s93, v253, v250
    ds_add_rtn_u32 v99, v107, v99 offset:13312
    v_and_or_b32 v108, s94, v253, v250
    ds_add_rtn_u32 v100, v108, v100 offset:13312
    v_or_b32 v104, s90, v250
    v_or_b32 v105, s91, v250
    v_or_b32 v106, s92, v250
    v_or_b32 v107, s93, v250
    v_or_b32 v108, s94, v250
    s_lshl_b32 s54, s3, 3
    s_add_u32 s61, s54, 7
    s_waitcnt lgkmcnt(3)
    v_lshl_or_b32 v96, v96, 16, v104
    ds_write_b32 v248, v96 offset:8192
    v_lshl_or_b32 v97, v97, 16, v105
    ds_write_b32 v248, v97 offset:8320
    s_waitcnt lgkmcnt(2)
    v_lshl_or_b32 v98, v98, 16, v106
    ds_write_b32 v248, v98 offset:8448
    v_lshl_or_b32 v99, v99, 16, v107
    ds_write_b32 v248, v99 offset:8576
    v_lshl_or_b32 v100, v100, 16, v108
    ds_write_b32 v248, v100 offset:8704
    s_mov_b32 exec_hi, -1
    buffer_load_dwordx4 v143, s[28:31], 0 offen offset:3072 sc1 lds
    s_add_u32 m0, s52, 4096
    s_nop 0
    buffer_load_dwordx4 v144, s[28:31], s98 offen offset:0 sc1 lds
    s_waitcnt lgkmcnt(0)
    s_barrier
    ds_read_b128 v[96:99], v2 offset:13312
    ds_read_b32 v132, v132 offset:8192
    ds_read_b32 v133, v133 offset:8192
    ds_read_b32 v134, v134 offset:8192
    s_waitcnt lgkmcnt(3)
    v_add_u32 v9, v96, v97
    v_add3_u32 v9, v9, v98, v99
    v_mov_b32 v10, v9
    s_waitcnt lgkmcnt(0)
    v_bfe_u32 v15, v132, 12, 3
    v_add_u32_dpp v10, v10, v10 row_shr:1 row_mask:0xf bank_mask:0xf
    v_or_b32 v150, v15, v150
    v_and_b32 v136, 0x3ff, v132
    v_add_u32_dpp v10, v10, v10 row_shr:2 row_mask:0xf bank_mask:0xf
    v_lshrrev_b32 v132, 16, v132
    v_add_u32 v132, v132, v128
    v_add_u32_dpp v10, v10, v10 row_shr:4 row_mask:0xf bank_mask:0xf
    v_bfe_u32 v15, v133, 12, 3
    v_or_b32 v154, v15, v154
    v_add_u32_dpp v10, v10, v10 row_shr:8 row_mask:0xf bank_mask:0xf
    v_and_b32 v137, 0x3ff, v133
    v_lshrrev_b32 v133, 16, v133
    v_add_u32_dpp v10, v10, v10 row_bcast:15 row_mask:0xa bank_mask:0xf
    v_add_u32 v133, v133, v129
    v_bfe_u32 v15, v134, 12, 3
    v_add_u32_dpp v10, v10, v10 row_bcast:31 row_mask:0xc bank_mask:0xf
    v_or_b32 v158, v15, v158
    v_and_b32 v138, 0x3ff, v134
    v_sub_u32 v9, v10, v9
    v_lshl_add_u32 v104, v9, 2, v252
    v_lshl_add_u32 v105, v96, 2, v104
    v_lshl_add_u32 v106, v97, 2, v105
    v_lshl_add_u32 v107, v98, 2, v106
    ds_write_b128 v2, v[104:107] offset:16384
    ds_read_b32 v136, v136 offset:16384
    ds_read_b32 v137, v137 offset:16384
    ds_read_b32 v138, v138 offset:16384
    v_lshrrev_b32 v134, 16, v134
    v_add_u32 v134, v134, v130
    v_readlane_b32 s50, v10, s61
    v_readlane_b32 s53, v9, s54
    v_readlane_b32 s51, v104, s54
    v_mov_b32 v14, 2097029
    s_sub_u32 s50, s50, s53
    s_lshl2_add_u32 s55, s50, s51
    v_add_u32 v9, s55, v201
    ds_write_b32 v9, v14
    s_add_u32 s53, s50, 15
    s_lshr_b32 s53, s53, 4
    s_sub_u32 s54, 0, s50
    s_and_b32 s54, s54, 14
    s_sub_u32 s53, s53, 1
    s_cmp_gt_i32 s53, 0
    s_cselect_b32 s54, s54, 0
    s_lshl_b32 s61, s54, 2
    s_sub_u32 s51, s51, s61
    s_waitcnt lgkmcnt(1)
    v_lshl_add_u32 v132, v132, 2, v136
    v_lshl_add_u32 v133, v133, 2, v137
    v_lshl_add_u32 v134, v134, 2, v138
    s_mov_b64 exec, s[80:81]
    ds_write_b32 v132, v150
    s_mov_b64 exec, s[82:83]
    ds_write_b32 v133, v154
    s_mov_b64 exec, s[84:85]
    ds_write_b32 v134, v158
    s_mov_b64 exec, -1
    s_cmp_gt_i32 s95, 192
    s_cbranch_scc1 L_r3
L_r3b:
    buffer_load_dwordx4 v145, s[28:31], s98 offen offset:1024 sc1 lds
    v_add_u32 v198, s51, v201
    v_add_u32 v199, s51, v202
    s_and_b32 s61, s61, 32
    v_add_u32 v12, s61, v198
    s_and_b32 s72, s54, 6
    s_mov_b32 s55, 0x00fffc38
    s_mov_b32 s49, 0xffffff00
    s_mov_b32 s51, 87040
    s_cmp_lt_u32 s3, 4
    s_cbranch_scc1 L_np
    s_setprio 1
L_np:
    s_waitcnt lgkmcnt(0)
    s_barrier
    ds_read_b32 v196, v12
    ds_read_b32 v194, v199
    ds_read_b32 v197, v198 offset:24
    ds_read_b32 v205, v251 offset:8192
    s_cmp_eq_u32 s50, 0
    s_cbranch_scc1 L_empty
    s_waitcnt lgkmcnt(3)
    v_lshlrev_b32 v196, 3, v196
    v_and_b32 v196, s55, v196
    s_cmp_eq_u32 s72, 2
    s_cbranch_scc1 L_p2
    s_cmp_eq_u32 s72, 4
    s_cbranch_scc1 L_p4
    s_cmp_eq_u32 s72, 6
    s_cbranch_scc1 L_p6
L_p0:
    v_readlane_b32 s64, v196, 0
    v_readlane_b32 s65, v196, 1
    s_and_b32 s61, s64, s49
    buffer_load_dwordx4 v[96:99], v2, s[16:19], s61 offen
    s_and_b32 s61, s65, s49
    buffer_load_dwordx4 v[100:103], v2, s[16:19], s61 offen
    s_waitcnt vmcnt(2) lgkmcnt(0)
    s_barrier
    v_lshrrev_b32 v8, 21, v194
    v_lshl_add_u32 v11, v8, 3, s51
    v_lshl_add_u32 v8, v8, 5, v200
    ds_read_b64 v[192:193], v11
    ds_read_b128 v[164:167], v8
    v_readlane_b32 s66, v196, 2
    v_readlane_b32 s67, v196, 3
    s_and_b32 s61, s66, s49
    buffer_load_dwordx4 v[104:107], v2, s[16:19], s61 offen
    s_and_b32 s61, s67, s49
    buffer_load_dwordx4 v[108:111], v2, s[16:19], s61 offen
    v_readlane_b32 s68, v196, 4
    v_readlane_b32 s69, v196, 5
    s_and_b32 s61, s68, s49
    buffer_load_dwordx4 v[112:115], v2, s[16:19], s61 offen
    s_and_b32 s61, s69, s49
    buffer_load_dwordx4 v[116:119], v2, s[16:19], s61 offen
    s_branch L_pd
L_p2:
    v_readlane_b32 s66, v196, 2
    v_readlane_b32 s67, v196, 3
    s_and_b32 s61, s66, s49
    buffer_load_dwordx4 v[104:107], v2, s[16:19], s61 offen
    s_and_b32 s61, s67, s49
    buffer_load_dwordx4 v[108:111], v2, s[16:19], s61 offen
    s_waitcnt vmcnt(2) lgkmcnt(0)
    s_barrier
    v_lshrrev_b32 v8, 21, v194
    v_lshl_add_u32 v11, v8, 3, s51
    v_lshl_add_u32 v8, v8, 5, v200
    ds_read_b64 v[192:193], v11
    ds_read_b128 v[164:167], v8
    v_readlane_b32 s68, v196, 4
    v_readlane_b32 s69, v196, 5
    s_and_b32 s61, s68, s49
    buffer_load_dwordx4 v[112:115], v2, s[16:19], s61 offen
    s_and_b32 s61, s69, s49
    buffer_load_dwordx4 v[116:119], v2, s[16:19], s61 offen
    v_readlane_b32 s70, v196, 6
    v_readlane_b32 s71, v196, 7
    s_and_b32 s61, s70, s49
    buffer_load_dwordx4 v[120:123], v2, s[16:19], s61 offen
    s_and_b32 s61, s71, s49
    buffer_load_dwordx4 v[124:127], v2, s[16:19], s61 offen
    s_branch L_pd
L_p4:
    v_readlane_b32 s68, v196, 4
    v_readlane_b32 s69, v196, 5
    s_and_b32 s61, s68, s49
    buffer_load_dwordx4 v[112:115], v2, s[16:19], s61 offen
    s_and_b32 s61, s69, s49
    buffer_load_dwordx4 v[116:119], v2, s[16:19], s61 offen
    s_waitcnt vmcnt(2) lgkmcnt(0)
    s_barrier
    v_lshrrev_b32 v8, 21, v194
    v_lshl_add_u32 v11, v8, 3, s51
    v_lshl_add_u32 v8, v8, 5, v200
    ds_read_b64 v[192:193], v11
    ds_read_b128 v[164:167], v8
    v_readlane_b32 s70, v196, 6
    v_readlane_b32 s71, v196, 7
    s_and_b32 s61, s70, s49
    buffer_load_dwordx4 v[120:123], v2, s[16:19], s61 offen
    s_and_b32 s61, s71, s49
    buffer_load_dwordx4 v[124:127], v2, s[16:19], s61 offen
    v_readlane_b32 s64, v196, 8
    v_readlane_b32 s65, v196, 9
    s_and_b32 s61, s64, s49
    buffer_load_dwordx4 v[96:99], v2, s[16:19], s61 offen
    s_and_b32 s61, s65, s49
    buffer_load_dwordx4 v[100:103], v2, s[16:19], s61 offen
    s_branch L_pd
L_p6:
    v_readlane_b32 s70, v196, 6
    v_readlane_b32 s71, v196, 7
    s_and_b32 s61, s70, s49
    buffer_load_dwordx4 v[120:123], v2, s[16:19], s61 offen
    s_and_b32 s61, s71, s49
    buffer_load_dwordx4 v[124:127], v2, s[16:19], s61 offen
    s_waitcnt vmcnt(2) lgkmcnt(0)
    s_barrier
    v_lshrrev_b32 v8, 21, v194
    v_lshl_add_u32 v11, v8, 3, s51
    v_lshl_add_u32 v8, v8, 5, v200
    ds_read_b64 v[192:193], v11
    ds_read_b128 v[164:167], v8
    v_readlane_b32 s64, v196, 8
    v_readlane_b32 s65, v196, 9
    s_and_b32 s61, s64, s49
    buffer_load_dwordx4 v[96:99], v2, s[16:19], s61 offen
    s_and_b32 s61, s65, s49
    buffer_load_dwordx4 v[100:103], v2, s[16:19], s61 offen
    v_readlane_b32 s66, v196, 10
    v_readlane_b32 s67, v196, 11
    s_and_b32 s61, s66, s49
    buffer_load_dwordx4 v[104:107], v2, s[16:19], s61 offen
    s_and_b32 s61, s67, s49
    buffer_load_dwordx4 v[108:111], v2, s[16:19], s61 offen
L_pd:
    s_waitcnt lgkmcnt(0)
    v_mfma_f32_4x4x4_16b_bf16 v[144:147], v[192:193], v[188:189], 0 cbsz:4 abid:0
    v_mfma_f32_4x4x4_16b_bf16 v[148:151], v[192:193], v[188:189], 0 cbsz:4 abid:2
    v_mfma_f32_4x4x4_16b_bf16 v[152:155], v[192:193], v[188:189], 0 cbsz:4 abid:4
    v_mfma_f32_4x4x4_16b_bf16 v[156:159], v[192:193], v[188:189], 0 cbsz:4 abid:6
    v_lshlrev_b32 v196, 3, v197
    v_and_b32 v196, s55, v196
    v_add_u32 v198, 64, v198
    v_add_u32 v199, 64, v199
    v_smfmac_f32_32x32x32_bf16 v[64:79], v[164:167], v[172:179], v168
    ds_read_b32 v197, v198 offset:24
    ds_read_b32 v194, v199
    v_smfmac_f32_32x32x32_bf16 v[80:95], v[164:167], v[180:187], v168
    s_set_gpr_idx_on s54, gpr_idx(SRC0,SRC1)
    v_cvt_pk_bf16_f32 v9, v144, v145
    s_set_gpr_idx_off
    v_perm_b32 v160, v9, v9, v190
    v_perm_b32 v161, v9, v9, v191
    s_waitcnt lgkmcnt(0)
    v_lshrrev_b32 v8, 21, v194
    v_lshl_add_u32 v11, v8, 3, s51
    v_lshl_add_u32 v8, v8, 5, v200
    ds_read_b64 v[192:193], v11
    ds_read_b128 v[164:167], v8
    s_cmp_eq_u32 s53, 0
    s_cbranch_scc1 L_f0
    s_cmp_eq_u32 s54, 0
    s_cbranch_scc1 L_j0
    s_cmp_eq_u32 s54, 2
    s_cbranch_scc1 L_j2
    ds_read_b128 v[64:67], v169
    ds_read_b128 v[80:83], v169
    s_cmp_eq_u32 s54, 4
    s_cbranch_scc1 L_j4
    s_cmp_eq_u32 s54, 6
    s_cbranch_scc1 L_j6
    ds_read_b128 v[68:71], v169
    ds_read_b128 v[84:87], v169
    s_cmp_eq_u32 s54, 8
    s_cbranch_scc1 L_j8
    s_cmp_eq_u32 s54, 10
    s_cbranch_scc1 L_j10
    ds_read_b128 v[72:75], v169
    ds_read_b128 v[88:91], v169
    s_cmp_eq_u32 s54, 12
    s_cbranch_scc1 L_j12
    s_branch L_j14
.p2align 3
L_loop:
    s_waitcnt lgkmcnt(2)
    v_mfma_f32_4x4x4_16b_bf16 v[144:147], v[192:193], v[188:189], 0 cbsz:4 abid:0
    v_mfma_f32_4x4x4_16b_bf16 v[148:151], v[192:193], v[188:189], 0 cbsz:4 abid:2
    v_mfma_f32_4x4x4_16b_bf16 v[152:155], v[192:193], v[188:189], 0 cbsz:4 abid:4
    v_mfma_f32_4x4x4_16b_bf16 v[156:159], v[192:193], v[188:189], 0 cbsz:4 abid:6
    v_lshlrev_b32 v196, 3, v197
    v_and_b32 v196, s55, v196
    v_add_u32 v198, 64, v198
    v_add_u32 v199, 64, v199
    s_waitcnt lgkmcnt(0)
    v_smfmac_f32_32x32x32_bf16 v[64:79], v[164:167], v[172:179], v168
    ds_read_b32 v197, v198 offset:24
    ds_read_b32 v194, v199
    v_cvt_pk_bf16_f32 v9, v144, v145
    v_perm_b32 v160, v9, v9, v190
    v_perm_b32 v161, v9, v9, v191
    v_smfmac_f32_32x32x32_bf16 v[80:95], v[164:167], v[180:187], v168
L_j0:
    s_waitcnt vmcnt(5)
    v_mfma_f32_16x16x16_bf16 v[128:131], v[160:161], v[96:97], 0
    v_readlane_b32 s70, v196, 0
    v_perm_b32 v162, v9, v9, v254
    v_mfma_f32_16x16x16_bf16 v[132:135], v[160:161], v[98:99], 0
    v_perm_b32 v163, v9, v9, v255
    s_and_b32 s61, s70, s49
    s_waitcnt vmcnt(4)
    buffer_load_dwordx4 v[120:123], v2, s[16:19], s61 offen
    v_mfma_f32_16x16x16_bf16 v[136:139], v[162:163], v[100:101], 0
    v_readlane_b32 s71, v196, 1
    v_cvt_pk_bf16_f32 v9, v146, v147
    v_mfma_f32_16x16x16_bf16 v[140:143], v[162:163], v[102:103], 0
    v_perm_b32 v160, v9, v9, v190
    v_perm_b32 v161, v9, v9, v191
    s_and_b32 s61, s71, s49
    s_set_gpr_idx_on s64, gpr_idx(SRC2,DST)
    buffer_load_dwordx4 v[124:127], v2, s[16:19], s61 offen
    v_pk_fma_f32 v[16:17], v[128:129], v[64:65], v[16:17] op_sel_hi:[1,0,1]
    v_pk_fma_f32 v[18:19], v[130:131], v[64:65], v[18:19] op_sel_hi:[1,0,1]
    v_pk_fma_f32 v[20:21], v[132:133], v[80:81], v[20:21] op_sel_hi:[1,0,1]
    v_pk_fma_f32 v[22:23], v[134:135], v[80:81], v[22:23] op_sel_hi:[1,0,1]
    s_set_gpr_idx_idx s65
    v_pk_fma_f32 v[16:17], v[136:137], v[64:65], v[16:17] op_sel:[0,1,0] op_sel_hi:[1,1,1]
    v_pk_fma_f32 v[18:19], v[138:139], v[64:65], v[18:19] op_sel:[0,1,0] op_sel_hi:[1,1,1]
    v_pk_fma_f32 v[20:21], v[140:141], v[80:81], v[20:21] op_sel:[0,1,0] op_sel_hi:[1,1,1]
    v_pk_fma_f32 v[22:23], v[142:143], v[80:81], v[22:23] op_sel:[0,1,0] op_sel_hi:[1,1,1]
    s_set_gpr_idx_off
L_j2:
    s_waitcnt vmcnt(5)
    v_mfma_f32_16x16x16_bf16 v[128:131], v[160:161], v[104:105], 0
    v_readlane_b32 s64, v196, 2
    v_perm_b32 v162, v9, v9, v254
    v_mfma_f32_16x16x16_bf16 v[132:135], v[160:161], v[106:107], 0
    v_perm_b32 v163, v9, v9, v255
    s_and_b32 s61, s64, s49
    s_waitcnt vmcnt(4)
    buffer_load_dwordx4 v[96:99], v2, s[16:19], s61 offen
    v_mfma_f32_16x16x16_bf16 v[136:139], v[162:163], v[108:109], 0
    v_readlane_b32 s65, v196, 3
    v_cvt_pk_bf16_f32 v9, v148, v149
    v_mfma_f32_16x16x16_bf16 v[140:143], v[162:163], v[110:111], 0
    v_perm_b32 v160, v9, v9, v190
    v_perm_b32 v161, v9, v9, v191
    s_waitcnt lgkmcnt(0)
    v_lshrrev_b32 v8, 21, v194
    v_lshl_add_u32 v11, v8, 3, s51
    v_lshl_add_u32 v8, v8, 5, v200
    ds_read_b64 v[192:193], v11
    ds_read_b128 v[164:167], v8
    s_and_b32 s61, s65, s49
    s_set_gpr_idx_on s66, gpr_idx(SRC2,DST)
    buffer_load_dwordx4 v[100:103], v2, s[16:19], s61 offen
    v_pk_fma_f32 v[16:17], v[128:129], v[66:67], v[16:17] op_sel_hi:[1,0,1]
    v_pk_fma_f32 v[18:19], v[130:131], v[66:67], v[18:19] op_sel_hi:[1,0,1]
    v_pk_fma_f32 v[20:21], v[132:133], v[82:83], v[20:21] op_sel_hi:[1,0,1]
    v_pk_fma_f32 v[22:23], v[134:135], v[82:83], v[22:23] op_sel_hi:[1,0,1]
    s_set_gpr_idx_idx s67
    v_pk_fma_f32 v[16:17], v[136:137], v[66:67], v[16:17] op_sel:[0,1,0] op_sel_hi:[1,1,1]
    v_pk_fma_f32 v[18:19], v[138:139], v[66:67], v[18:19] op_sel:[0,1,0] op_sel_hi:[1,1,1]
    v_pk_fma_f32 v[20:21], v[140:141], v[82:83], v[20:21] op_sel:[0,1,0] op_sel_hi:[1,1,1]
    v_pk_fma_f32 v[22:23], v[142:143], v[82:83], v[22:23] op_sel:[0,1,0] op_sel_hi:[1,1,1]
    ds_read_b128 v[64:67], v169
    ds_read_b128 v[80:83], v169
    s_set_gpr_idx_off
L_j4:
    s_waitcnt vmcnt(5)
    v_mfma_f32_16x16x16_bf16 v[128:131], v[160:161], v[112:113], 0
    v_readlane_b32 s66, v196, 4
    v_perm_b32 v162, v9, v9, v254
    v_mfma_f32_16x16x16_bf16 v[132:135], v[160:161], v[114:115], 0
    v_perm_b32 v163, v9, v9, v255
    s_and_b32 s61, s66, s49
    s_waitcnt vmcnt(4)
    buffer_load_dwordx4 v[104:107], v2, s[16:19], s61 offen
    v_mfma_f32_16x16x16_bf16 v[136:139], v[162:163], v[116:117], 0
    v_readlane_b32 s67, v196, 5
    v_cvt_pk_bf16_f32 v9, v150, v151
    v_mfma_f32_16x16x16_bf16 v[140:143], v[162:163], v[118:119], 0
    v_perm_b32 v160, v9, v9, v190
    v_perm_b32 v161, v9, v9, v191
    s_and_b32 s61, s67, s49
    s_set_gpr_idx_on s68, gpr_idx(SRC2,DST)
    buffer_load_dwordx4 v[108:111], v2, s[16:19], s61 offen
    v_pk_fma_f32 v[16:17], v[128:129], v[68:69], v[16:17] op_sel_hi:[1,0,1]
    v_pk_fma_f32 v[18:19], v[130:131], v[68:69], v[18:19] op_sel_hi:[1,0,1]
    v_pk_fma_f32 v[20:21], v[132:133], v[84:85], v[20:21] op_sel_hi:[1,0,1]
    v_pk_fma_f32 v[22:23], v[134:135], v[84:85], v[22:23] op_sel_hi:[1,0,1]
    s_set_gpr_idx_idx s69
    v_pk_fma_f32 v[16:17], v[136:137], v[68:69], v[16:17] op_sel:[0,1,0] op_sel_hi:[1,1,1]
    v_pk_fma_f32 v[18:19], v[138:139], v[68:69], v[18:19] op_sel:[0,1,0] op_sel_hi:[1,1,1]
    v_pk_fma_f32 v[20:21], v[140:141], v[84:85], v[20:21] op_sel:[0,1,0] op_sel_hi:[1,1,1]
    v_pk_fma_f32 v[22:23], v[142:143], v[84:85], v[22:23] op_sel:[0,1,0] op_sel_hi:[1,1,1]
    s_set_gpr_idx_off
L_j6:
    s_waitcnt vmcnt(5)
    v_mfma_f32_16x16x16_bf16 v[128:131], v[160:161], v[120:121], 0
    v_readlane_b32 s68, v196, 6
    v_perm_b32 v162, v9, v9, v254
    v_mfma_f32_16x16x16_bf16 v[132:135], v[160:161], v[122:123], 0
    v_perm_b32 v163, v9, v9, v255
    s_and_b32 s61, s68, s49
    s_waitcnt vmcnt(4)
    buffer_load_dwordx4 v[112:115], v2, s[16:19], s61 offen
    v_mfma_f32_16x16x16_bf16 v[136:139], v[162:163], v[124:125], 0
    v_readlane_b32 s69, v196, 7
    v_cvt_pk_bf16_f32 v9, v152, v153
    v_mfma_f32_16x16x16_bf16 v[140:143], v[162:163], v[126:127], 0
    v_perm_b32 v160, v9, v9, v190
    v_perm_b32 v161, v9, v9, v191
    s_and_b32 s61, s69, s49
    s_set_gpr_idx_on s70, gpr_idx(SRC2,DST)
    buffer_load_dwordx4 v[116:119], v2, s[16:19], s61 offen
    v_pk_fma_f32 v[16:17], v[128:129], v[70:71], v[16:17] op_sel_hi:[1,0,1]
    v_pk_fma_f32 v[18:19], v[130:131], v[70:71], v[18:19] op_sel_hi:[1,0,1]
    v_pk_fma_f32 v[20:21], v[132:133], v[86:87], v[20:21] op_sel_hi:[1,0,1]
    v_pk_fma_f32 v[22:23], v[134:135], v[86:87], v[22:23] op_sel_hi:[1,0,1]
    s_set_gpr_idx_idx s71
    v_pk_fma_f32 v[16:17], v[136:137], v[70:71], v[16:17] op_sel:[0,1,0] op_sel_hi:[1,1,1]
    v_pk_fma_f32 v[18:19], v[138:139], v[70:71], v[18:19] op_sel:[0,1,0] op_sel_hi:[1,1,1]
    v_pk_fma_f32 v[20:21], v[140:141], v[86:87], v[20:21] op_sel:[0,1,0] op_sel_hi:[1,1,1]
    v_pk_fma_f32 v[22:23], v[142:143], v[86:87], v[22:23] op_sel:[0,1,0] op_sel_hi:[1,1,1]
    ds_read_b128 v[68:71], v169
    ds_read_b128 v[84:87], v169
    s_set_gpr_idx_off
L_j8:
    s_waitcnt vmcnt(5)
    v_mfma_f32_16x16x16_bf16 v[128:131], v[160:161], v[96:97], 0
    v_readlane_b32 s70, v196, 8
    v_perm_b32 v162, v9, v9, v254
    v_mfma_f32_16x16x16_bf16 v[132:135], v[160:161], v[98:99], 0
    v_perm_b32 v163, v9, v9, v255
    s_and_b32 s61, s70, s49
    s_waitcnt vmcnt(4)
    buffer_load_dwordx4 v[120:123], v2, s[16:19], s61 offen
    v_mfma_f32_16x16x16_bf16 v[136:139], v[162:163], v[100:101], 0
    v_readlane_b32 s71, v196, 9
    v_cvt_pk_bf16_f32 v9, v154, v155
    v_mfma_f32_16x16x16_bf16 v[140:143], v[162:163], v[102:103], 0
    v_perm_b32 v160, v9, v9, v190
    v_perm_b32 v161, v9, v9, v191
    s_and_b32 s61, s71, s49
    s_set_gpr_idx_on s64, gpr_idx(SRC2,DST)
    buffer_load_dwordx4 v[124:127], v2, s[16:19], s61 offen
    v_pk_fma_f32 v[16:17], v[128:129], v[72:73], v[16:17] op_sel_hi:[1,0,1]
    v_pk_fma_f32 v[18:19], v[130:131], v[72:73], v[18:19] op_sel_hi:[1,0,1]
    v_pk_fma_f32 v[20:21], v[132:133], v[88:89], v[20:21] op_sel_hi:[1,0,1]
    v_pk_fma_f32 v[22:23], v[134:135], v[88:89], v[22:23] op_sel_hi:[1,0,1]
    s_set_gpr_idx_idx s65
    v_pk_fma_f32 v[16:17], v[136:137], v[72:73], v[16:17] op_sel:[0,1,0] op_sel_hi:[1,1,1]
    v_pk_fma_f32 v[18:19], v[138:139], v[72:73], v[18:19] op_sel:[0,1,0] op_sel_hi:[1,1,1]
    v_pk_fma_f32 v[20:21], v[140:141], v[88:89], v[20:21] op_sel:[0,1,0] op_sel_hi:[1,1,1]
    v_pk_fma_f32 v[22:23], v[142:143], v[88:89], v[22:23] op_sel:[0,1,0] op_sel_hi:[1,1,1]
    s_set_gpr_idx_off
L_j10:
    s_waitcnt vmcnt(5)
    v_mfma_f32_16x16x16_bf16 v[128:131], v[160:161], v[104:105], 0
    v_readlane_b32 s64, v196, 10
    v_perm_b32 v162, v9, v9, v254
    v_mfma_f32_16x16x16_bf16 v[132:135], v[160:161], v[106:107], 0
    v_perm_b32 v163, v9, v9, v255
    s_and_b32 s61, s64, s49
    s_waitcnt vmcnt(4)
    buffer_load_dwordx4 v[96:99], v2, s[16:19], s61 offen
    v_mfma_f32_16x16x16_bf16 v[136:139], v[162:163], v[108:109], 0
    v_readlane_b32 s65, v196, 11
    v_cvt_pk_bf16_f32 v9, v156, v157
    v_mfma_f32_16x16x16_bf16 v[140:143], v[162:163], v[110:111], 0
    v_perm_b32 v160, v9, v9, v190
    v_perm_b32 v161, v9, v9, v191
    s_and_b32 s61, s65, s49
    s_set_gpr_idx_on s66, gpr_idx(SRC2,DST)
    buffer_load_dwordx4 v[100:103], v2, s[16:19], s61 offen
    v_pk_fma_f32 v[16:17], v[128:129], v[74:75], v[16:17] op_sel_hi:[1,0,1]
    v_pk_fma_f32 v[18:19], v[130:131], v[74:75], v[18:19] op_sel_hi:[1,0,1]
    v_pk_fma_f32 v[20:21], v[132:133], v[90:91], v[20:21] op_sel_hi:[1,0,1]
    v_pk_fma_f32 v[22:23], v[134:135], v[90:91], v[22:23] op_sel_hi:[1,0,1]
    s_set_gpr_idx_idx s67
    v_pk_fma_f32 v[16:17], v[136:137], v[74:75], v[16:17] op_sel:[0,1,0] op_sel_hi:[1,1,1]
    v_pk_fma_f32 v[18:19], v[138:139], v[74:75], v[18:19] op_sel:[0,1,0] op_sel_hi:[1,1,1]
    v_pk_fma_f32 v[20:21], v[140:141], v[90:91], v[20:21] op_sel:[0,1,0] op_sel_hi:[1,1,1]
    v_pk_fma_f32 v[22:23], v[142:143], v[90:91], v[22:23] op_sel:[0,1,0] op_sel_hi:[1,1,1]
    ds_read_b128 v[72:75], v169
    ds_read_b128 v[88:91], v169
    s_set_gpr_idx_off
L_j12:
    s_waitcnt vmcnt(5)
    v_mfma_f32_16x16x16_bf16 v[128:131], v[160:161], v[112:113], 0
    v_readlane_b32 s66, v196, 12
    v_perm_b32 v162, v9, v9, v254
    v_mfma_f32_16x16x16_bf16 v[132:135], v[160:161], v[114:115], 0
    v_perm_b32 v163, v9, v9, v255
    s_and_b32 s61, s66, s49
    s_waitcnt vmcnt(4)
    buffer_load_dwordx4 v[104:107], v2, s[16:19], s61 offen
    v_mfma_f32_16x16x16_bf16 v[136:139], v[162:163], v[116:117], 0
    v_readlane_b32 s67, v196, 13
    v_cvt_pk_bf16_f32 v9, v158, v159
    v_mfma_f32_16x16x16_bf16 v[140:143], v[162:163], v[118:119], 0
    v_perm_b32 v160, v9, v9, v190
    v_perm_b32 v161, v9, v9, v191
    s_and_b32 s61, s67, s49
    s_set_gpr_idx_on s68, gpr_idx(SRC2,DST)
    buffer_load_dwordx4 v[108:111], v2, s[16:19], s61 offen
    v_pk_fma_f32 v[16:17], v[128:129], v[76:77], v[16:17] op_sel_hi:[1,0,1]
    v_pk_fma_f32 v[18:19], v[130:131], v[76:77], v[18:19] op_sel_hi:[1,0,1]
    v_pk_fma_f32 v[20:21], v[132:133], v[92:93], v[20:21] op_sel_hi:[1,0,1]
    v_pk_fma_f32 v[22:23], v[134:135], v[92:93], v[22:23] op_sel_hi:[1,0,1]
    s_set_gpr_idx_idx s69
    v_pk_fma_f32 v[16:17], v[136:137], v[76:77], v[16:17] op_sel:[0,1,0] op_sel_hi:[1,1,1]
    v_pk_fma_f32 v[18:19], v[138:139], v[76:77], v[18:19] op_sel:[0,1,0] op_sel_hi:[1,1,1]
    v_pk_fma_f32 v[20:21], v[140:141], v[92:93], v[20:21] op_sel:[0,1,0] op_sel_hi:[1,1,1]
    v_pk_fma_f32 v[22:23], v[142:143], v[92:93], v[22:23] op_sel:[0,1,0] op_sel_hi:[1,1,1]
    s_set_gpr_idx_off
L_j14:
    s_waitcnt vmcnt(5)
    v_mfma_f32_16x16x16_bf16 v[128:131], v[160:161], v[120:121], 0
    v_readlane_b32 s68, v196, 14
    v_perm_b32 v162, v9, v9, v254
    v_mfma_f32_16x16x16_bf16 v[132:135], v[160:161], v[122:123], 0
    v_perm_b32 v163, v9, v9, v255
    s_and_b32 s61, s68, s49
    s_waitcnt vmcnt(4)
    buffer_load_dwordx4 v[112:115], v2, s[16:19], s61 offen
    v_mfma_f32_16x16x16_bf16 v[136:139], v[162:163], v[124:125], 0
    v_readlane_b32 s69, v196, 15
    v_mfma_f32_16x16x16_bf16 v[140:143], v[162:163], v[126:127], 0
    s_and_b32 s61, s69, s49
    s_set_gpr_idx_on s70, gpr_idx(SRC2,DST)
    buffer_load_dwordx4 v[116:119], v2, s[16:19], s61 offen
    v_pk_fma_f32 v[16:17], v[128:129], v[78:79], v[16:17] op_sel_hi:[1,0,1]
    v_pk_fma_f32 v[18:19], v[130:131], v[78:79], v[18:19] op_sel_hi:[1,0,1]
    v_pk_fma_f32 v[20:21], v[132:133], v[94:95], v[20:21] op_sel_hi:[1,0,1]
    v_pk_fma_f32 v[22:23], v[134:135], v[94:95], v[22:23] op_sel_hi:[1,0,1]
    s_set_gpr_idx_idx s71
    s_sub_u32 s53, s53, 1
    v_pk_fma_f32 v[16:17], v[136:137], v[78:79], v[16:17] op_sel:[0,1,0] op_sel_hi:[1,1,1]
    v_pk_fma_f32 v[18:19], v[138:139], v[78:79], v[18:19] op_sel:[0,1,0] op_sel_hi:[1,1,1]
    v_pk_fma_f32 v[20:21], v[140:141], v[94:95], v[20:21] op_sel:[0,1,0] op_sel_hi:[1,1,1]
    v_pk_fma_f32 v[22:23], v[142:143], v[94:95], v[22:23] op_sel:[0,1,0] op_sel_hi:[1,1,1]
    ds_read_b128 v[76:79], v169
    ds_read_b128 v[92:95], v169
    s_set_gpr_idx_off
    s_cmp_lg_u32 s53, 0
    s_cbranch_scc1 L_loop
    s_waitcnt lgkmcnt(2)
    v_mfma_f32_4x4x4_16b_bf16 v[144:147], v[192:193], v[188:189], 0 cbsz:4 abid:0
    v_mfma_f32_4x4x4_16b_bf16 v[148:151], v[192:193], v[188:189], 0 cbsz:4 abid:2
    v_mfma_f32_4x4x4_16b_bf16 v[152:155], v[192:193], v[188:189], 0 cbsz:4 abid:4
    v_mfma_f32_4x4x4_16b_bf16 v[156:159], v[192:193], v[188:189], 0 cbsz:4 abid:6
    v_lshlrev_b32 v196, 3, v197
    v_and_b32 v196, s55, v196
    s_waitcnt lgkmcnt(0)
    v_smfmac_f32_32x32x32_bf16 v[64:79], v[164:167], v[172:179], v168
    v_cvt_pk_bf16_f32 v9, v144, v145
    v_perm_b32 v160, v9, v9, v190
    v_perm_b32 v161, v9, v9, v191
    v_smfmac_f32_32x32x32_bf16 v[80:95], v[164:167], v[180:187], v168
L_f0:
    s_waitcnt vmcnt(5)
    v_mfma_f32_16x16x16_bf16 v[128:131], v[160:161], v[96:97], 0
    v_readlane_b32 s70, v196, 0
    v_perm_b32 v162, v9, v9, v254
    v_mfma_f32_16x16x16_bf16 v[132:135], v[160:161], v[98:99], 0
    v_perm_b32 v163, v9, v9, v255
    s_and_b32 s61, s70, s49
    s_waitcnt vmcnt(4)
    buffer_load_dwordx4 v[120:123], v2, s[16:19], s61 offen
    v_mfma_f32_16x16x16_bf16 v[136:139], v[162:163], v[100:101], 0
    v_readlane_b32 s71, v196, 1
    v_cvt_pk_bf16_f32 v9, v146, v147
    v_mfma_f32_16x16x16_bf16 v[140:143], v[162:163], v[102:103], 0
    v_perm_b32 v160, v9, v9, v190
    v_perm_b32 v161, v9, v9, v191
    s_and_b32 s61, s71, s49
    s_set_gpr_idx_on s64, gpr_idx(SRC2,DST)
    buffer_load_dwordx4 v[124:127], v2, s[16:19], s61 offen
    v_pk_fma_f32 v[16:17], v[128:129], v[64:65], v[16:17] op_sel_hi:[1,0,1]
    v_pk_fma_f32 v[18:19], v[130:131], v[64:65], v[18:19] op_sel_hi:[1,0,1]
    v_pk_fma_f32 v[20:21], v[132:133], v[80:81], v[20:21] op_sel_hi:[1,0,1]
    v_pk_fma_f32 v[22:23], v[134:135], v[80:81], v[22:23] op_sel_hi:[1,0,1]
    s_set_gpr_idx_idx s65
    v_pk_fma_f32 v[16:17], v[136:137], v[64:65], v[16:17] op_sel:[0,1,0] op_sel_hi:[1,1,1]
    v_pk_fma_f32 v[18:19], v[138:139], v[64:65], v[18:19] op_sel:[0,1,0] op_sel_hi:[1,1,1]
    v_pk_fma_f32 v[20:21], v[140:141], v[80:81], v[20:21] op_sel:[0,1,0] op_sel_hi:[1,1,1]
    v_pk_fma_f32 v[22:23], v[142:143], v[80:81], v[22:23] op_sel:[0,1,0] op_sel_hi:[1,1,1]
    s_set_gpr_idx_off
    s_waitcnt vmcnt(5)
    v_mfma_f32_16x16x16_bf16 v[128:131], v[160:161], v[104:105], 0
    v_readlane_b32 s64, v196, 2
    v_perm_b32 v162, v9, v9, v254
    v_mfma_f32_16x16x16_bf16 v[132:135], v[160:161], v[106:107], 0
    v_perm_b32 v163, v9, v9, v255
    s_and_b32 s61, s64, s49
    s_waitcnt vmcnt(4)
    buffer_load_dwordx4 v[96:99], v2, s[16:19], s61 offen
    v_mfma_f32_16x16x16_bf16 v[136:139], v[162:163], v[108:109], 0
    v_readlane_b32 s65, v196, 3
    v_cvt_pk_bf16_f32 v9, v148, v149
    v_mfma_f32_16x16x16_bf16 v[140:143], v[162:163], v[110:111], 0
    v_perm_b32 v160, v9, v9, v190
    v_perm_b32 v161, v9, v9, v191
    v_lshlrev_b32 v12, 2, v1
    s_lshl_b32 s61, s3, 7
    v_and_b32 v205, 0x7380, v205
    v_xor_b32 v205, s61, v205
    v_alignbit_b32 v205, v205, v205, 12
    v_cmp_eq_u32 s[80:81], 0, v205
    v_cmp_eq_u32 s[82:83], 1, v205
    v_cmp_eq_u32 s[84:85], 2, v205
    v_cmp_eq_u32 s[96:97], 3, v205
    v_cmp_eq_u32 vcc, 4, v205
    s_ff1_i32_b64 s56, s[80:81]
    s_mul_i32 s56, s56, 1152
    v_add_u32 v208, s56, v12
    s_ff1_i32_b64 s57, s[82:83]
    s_mul_i32 s57, s57, 1152
    v_add_u32 v209, s57, v12
    s_ff1_i32_b64 s58, s[84:85]
    s_mul_i32 s58, s58, 1152
    v_add_u32 v210, s58, v12
    s_ff1_i32_b64 s59, s[96:97]
    s_mul_i32 s59, s59, 1152
    v_add_u32 v211, s59, v12
    s_ff1_i32_b64 s60, vcc
    s_mul_i32 s60, s60, 1152
    v_add_u32 v212, s60, v12
    s_and_b32 s61, s65, s49
    s_set_gpr_idx_on s66, gpr_idx(SRC2,DST)
    buffer_load_dwordx4 v[100:103], v2, s[16:19], s61 offen
    v_pk_fma_f32 v[16:17], v[128:129], v[66:67], v[16:17] op_sel_hi:[1,0,1]
    v_pk_fma_f32 v[18:19], v[130:131], v[66:67], v[18:19] op_sel_hi:[1,0,1]
    v_pk_fma_f32 v[20:21], v[132:133], v[82:83], v[20:21] op_sel_hi:[1,0,1]
    v_pk_fma_f32 v[22:23], v[134:135], v[82:83], v[22:23] op_sel_hi:[1,0,1]
    s_set_gpr_idx_idx s67
    v_pk_fma_f32 v[16:17], v[136:137], v[66:67], v[16:17] op_sel:[0,1,0] op_sel_hi:[1,1,1]
    v_pk_fma_f32 v[18:19], v[138:139], v[66:67], v[18:19] op_sel:[0,1,0] op_sel_hi:[1,1,1]
    v_pk_fma_f32 v[20:21], v[140:141], v[82:83], v[20:21] op_sel:[0,1,0] op_sel_hi:[1,1,1]
    v_pk_fma_f32 v[22:23], v[142:143], v[82:83], v[22:23] op_sel:[0,1,0] op_sel_hi:[1,1,1]
    s_set_gpr_idx_off
    s_waitcnt vmcnt(5)
    v_mfma_f32_16x16x16_bf16 v[128:131], v[160:161], v[112:113], 0
    v_readlane_b32 s66, v196, 4
    v_perm_b32 v162, v9, v9, v254
    v_mfma_f32_16x16x16_bf16 v[132:135], v[160:161], v[114:115], 0
    v_perm_b32 v163, v9, v9, v255
    s_and_b32 s61, s66, s49
    s_waitcnt vmcnt(4)
    buffer_load_dwordx4 v[104:107], v2, s[16:19], s61 offen
    v_mfma_f32_16x16x16_bf16 v[136:139], v[162:163], v[116:117], 0
    v_readlane_b32 s67, v196, 5
    v_cvt_pk_bf16_f32 v9, v150, v151
    v_mfma_f32_16x16x16_bf16 v[140:143], v[162:163], v[118:119], 0
    v_perm_b32 v160, v9, v9, v190
    v_perm_b32 v161, v9, v9, v191
    s_and_b32 s61, s67, s49
    s_set_gpr_idx_on s68, gpr_idx(SRC2,DST)
    buffer_load_dwordx4 v[108:111], v2, s[16:19], s61 offen
    v_pk_fma_f32 v[16:17], v[128:129], v[68:69], v[16:17] op_sel_hi:[1,0,1]
    v_pk_fma_f32 v[18:19], v[130:131], v[68:69], v[18:19] op_sel_hi:[1,0,1]
    v_pk_fma_f32 v[20:21], v[132:133], v[84:85], v[20:21] op_sel_hi:[1,0,1]
    v_pk_fma_f32 v[22:23], v[134:135], v[84:85], v[22:23] op_sel_hi:[1,0,1]
    s_set_gpr_idx_idx s69
    v_pk_fma_f32 v[16:17], v[136:137], v[68:69], v[16:17] op_sel:[0,1,0] op_sel_hi:[1,1,1]
    v_pk_fma_f32 v[18:19], v[138:139], v[68:69], v[18:19] op_sel:[0,1,0] op_sel_hi:[1,1,1]
    v_pk_fma_f32 v[20:21], v[140:141], v[84:85], v[20:21] op_sel:[0,1,0] op_sel_hi:[1,1,1]
    v_pk_fma_f32 v[22:23], v[142:143], v[84:85], v[22:23] op_sel:[0,1,0] op_sel_hi:[1,1,1]
    s_set_gpr_idx_off
    s_waitcnt vmcnt(5)
    v_mfma_f32_16x16x16_bf16 v[128:131], v[160:161], v[120:121], 0
    v_readlane_b32 s68, v196, 6
    v_perm_b32 v162, v9, v9, v254
    v_mfma_f32_16x16x16_bf16 v[132:135], v[160:161], v[122:123], 0
    v_perm_b32 v163, v9, v9, v255
    s_and_b32 s61, s68, s49
    s_waitcnt vmcnt(4)
    buffer_load_dwordx4 v[112:115], v2, s[16:19], s61 offen
    v_mfma_f32_16x16x16_bf16 v[136:139], v[162:163], v[124:125], 0
    v_readlane_b32 s69, v196, 7
    v_cvt_pk_bf16_f32 v9, v152, v153
    v_mfma_f32_16x16x16_bf16 v[140:143], v[162:163], v[126:127], 0
    v_perm_b32 v160, v9, v9, v190
    v_perm_b32 v161, v9, v9, v191
    s_and_b32 s61, s69, s49
    s_set_gpr_idx_on s70, gpr_idx(SRC2,DST)
    buffer_load_dwordx4 v[116:119], v2, s[16:19], s61 offen
    v_pk_fma_f32 v[16:17], v[128:129], v[70:71], v[16:17] op_sel_hi:[1,0,1]
    v_pk_fma_f32 v[18:19], v[130:131], v[70:71], v[18:19] op_sel_hi:[1,0,1]
    v_pk_fma_f32 v[20:21], v[132:133], v[86:87], v[20:21] op_sel_hi:[1,0,1]
    v_pk_fma_f32 v[22:23], v[134:135], v[86:87], v[22:23] op_sel_hi:[1,0,1]
    s_set_gpr_idx_idx s71
    v_pk_fma_f32 v[16:17], v[136:137], v[70:71], v[16:17] op_sel:[0,1,0] op_sel_hi:[1,1,1]
    v_pk_fma_f32 v[18:19], v[138:139], v[70:71], v[18:19] op_sel:[0,1,0] op_sel_hi:[1,1,1]
    v_pk_fma_f32 v[20:21], v[140:141], v[86:87], v[20:21] op_sel:[0,1,0] op_sel_hi:[1,1,1]
    v_pk_fma_f32 v[22:23], v[142:143], v[86:87], v[22:23] op_sel:[0,1,0] op_sel_hi:[1,1,1]
    ds_read_b128 v[144:147], v215 offset:14336
    ds_read_b128 v[148:151], v215 offset:15360
    s_set_gpr_idx_off
    s_waitcnt vmcnt(5)
    v_mfma_f32_16x16x16_bf16 v[128:131], v[160:161], v[96:97], 0
    v_readlane_b32 s70, v196, 8
    v_perm_b32 v162, v9, v9, v254
    v_mfma_f32_16x16x16_bf16 v[132:135], v[160:161], v[98:99], 0
    v_perm_b32 v163, v9, v9, v255
    s_and_b32 s61, s70, s49
    s_waitcnt vmcnt(4)
    buffer_load_dwordx4 v[120:123], v2, s[16:19], s61 offen
    v_mfma_f32_16x16x16_bf16 v[136:139], v[162:163], v[100:101], 0
    v_readlane_b32 s71, v196, 9
    v_cvt_pk_bf16_f32 v9, v154, v155
    v_mfma_f32_16x16x16_bf16 v[140:143], v[162:163], v[102:103], 0
    v_perm_b32 v160, v9, v9, v190
    v_perm_b32 v161, v9, v9, v191
    s_and_b32 s61, s71, s49
    s_set_gpr_idx_on s64, gpr_idx(SRC2,DST)
    buffer_load_dwordx4 v[124:127], v2, s[16:19], s61 offen
    v_pk_fma_f32 v[16:17], v[128:129], v[72:73], v[16:17] op_sel_hi:[1,0,1]
    v_pk_fma_f32 v[18:19], v[130:131], v[72:73], v[18:19] op_sel_hi:[1,0,1]
    v_pk_fma_f32 v[20:21], v[132:133], v[88:89], v[20:21] op_sel_hi:[1,0,1]
    v_pk_fma_f32 v[22:23], v[134:135], v[88:89], v[22:23] op_sel_hi:[1,0,1]
    s_set_gpr_idx_idx s65
    v_pk_fma_f32 v[16:17], v[136:137], v[72:73], v[16:17] op_sel:[0,1,0] op_sel_hi:[1,1,1]
    v_pk_fma_f32 v[18:19], v[138:139], v[72:73], v[18:19] op_sel:[0,1,0] op_sel_hi:[1,1,1]
    v_pk_fma_f32 v[20:21], v[140:141], v[88:89], v[20:21] op_sel:[0,1,0] op_sel_hi:[1,1,1]
    v_pk_fma_f32 v[22:23], v[142:143], v[88:89], v[22:23] op_sel:[0,1,0] op_sel_hi:[1,1,1]
    ds_read_b128 v[96:99], v215 offset:6144
    ds_read_b128 v[100:103], v215 offset:7168
    s_set_gpr_idx_off
    s_waitcnt vmcnt(5)
    v_mfma_f32_16x16x16_bf16 v[128:131], v[160:161], v[104:105], 0
    v_perm_b32 v162, v9, v9, v254
    v_mfma_f32_16x16x16_bf16 v[132:135], v[160:161], v[106:107], 0
    v_perm_b32 v163, v9, v9, v255
    s_waitcnt vmcnt(4)
    s_nop 0
    v_mfma_f32_16x16x16_bf16 v[136:139], v[162:163], v[108:109], 0
    v_cvt_pk_bf16_f32 v9, v156, v157
    v_mfma_f32_16x16x16_bf16 v[140:143], v[162:163], v[110:111], 0
    v_perm_b32 v160, v9, v9, v190
    v_perm_b32 v161, v9, v9, v191
    s_set_gpr_idx_on s66, gpr_idx(SRC2,DST)
    v_pk_fma_f32 v[16:17], v[128:129], v[74:75], v[16:17] op_sel_hi:[1,0,1]
    v_pk_fma_f32 v[18:19], v[130:131], v[74:75], v[18:19] op_sel_hi:[1,0,1]
    v_pk_fma_f32 v[20:21], v[132:133], v[90:91], v[20:21] op_sel_hi:[1,0,1]
    v_pk_fma_f32 v[22:23], v[134:135], v[90:91], v[22:23] op_sel_hi:[1,0,1]
    s_set_gpr_idx_idx s67
    v_pk_fma_f32 v[16:17], v[136:137], v[74:75], v[16:17] op_sel:[0,1,0] op_sel_hi:[1,1,1]
    v_pk_fma_f32 v[18:19], v[138:139], v[74:75], v[18:19] op_sel:[0,1,0] op_sel_hi:[1,1,1]
    v_pk_fma_f32 v[20:21], v[140:141], v[90:91], v[20:21] op_sel:[0,1,0] op_sel_hi:[1,1,1]
    v_pk_fma_f32 v[22:23], v[142:143], v[90:91], v[22:23] op_sel:[0,1,0] op_sel_hi:[1,1,1]
    ds_read_b128 v[104:107], v215 offset:8192
    ds_read_b128 v[108:111], v215 offset:9216
    s_set_gpr_idx_off
    s_waitcnt vmcnt(3)
    v_mfma_f32_16x16x16_bf16 v[128:131], v[160:161], v[112:113], 0
    v_perm_b32 v162, v9, v9, v254
    v_mfma_f32_16x16x16_bf16 v[132:135], v[160:161], v[114:115], 0
    v_perm_b32 v163, v9, v9, v255
    s_waitcnt vmcnt(2)
    s_nop 0
    v_mfma_f32_16x16x16_bf16 v[136:139], v[162:163], v[116:117], 0
    v_cvt_pk_bf16_f32 v9, v158, v159
    v_mfma_f32_16x16x16_bf16 v[140:143], v[162:163], v[118:119], 0
    v_perm_b32 v160, v9, v9, v190
    v_perm_b32 v161, v9, v9, v191
    s_set_gpr_idx_on s68, gpr_idx(SRC2,DST)
    v_pk_fma_f32 v[16:17], v[128:129], v[76:77], v[16:17] op_sel_hi:[1,0,1]
    v_pk_fma_f32 v[18:19], v[130:131], v[76:77], v[18:19] op_sel_hi:[1,0,1]
    v_pk_fma_f32 v[20:21], v[132:133], v[92:93], v[20:21] op_sel_hi:[1,0,1]
    v_pk_fma_f32 v[22:23], v[134:135], v[92:93], v[22:23] op_sel_hi:[1,0,1]
    s_set_gpr_idx_idx s69
    v_pk_fma_f32 v[16:17], v[136:137], v[76:77], v[16:17] op_sel:[0,1,0] op_sel_hi:[1,1,1]
    v_pk_fma_f32 v[18:19], v[138:139], v[76:77], v[18:19] op_sel:[0,1,0] op_sel_hi:[1,1,1]
    v_pk_fma_f32 v[20:21], v[140:141], v[92:93], v[20:21] op_sel:[0,1,0] op_sel_hi:[1,1,1]
    v_pk_fma_f32 v[22:23], v[142:143], v[92:93], v[22:23] op_sel:[0,1,0] op_sel_hi:[1,1,1]
    ds_read_b128 v[112:115], v215 offset:10240
    ds_read_b128 v[116:119], v215 offset:11264
    s_set_gpr_idx_off
    s_waitcnt vmcnt(1)
    v_mfma_f32_16x16x16_bf16 v[128:131], v[160:161], v[120:121], 0
    v_perm_b32 v162, v9, v9, v254
    v_mfma_f32_16x16x16_bf16 v[132:135], v[160:161], v[122:123], 0
    v_perm_b32 v163, v9, v9, v255
    s_waitcnt vmcnt(0)
    s_nop 0
    v_mfma_f32_16x16x16_bf16 v[136:139], v[162:163], v[124:125], 0
    v_mfma_f32_16x16x16_bf16 v[140:143], v[162:163], v[126:127], 0
    s_set_gpr_idx_on s70, gpr_idx(SRC2,DST)
    v_pk_fma_f32 v[16:17], v[128:129], v[78:79], v[16:17] op_sel_hi:[1,0,1]
    v_pk_fma_f32 v[18:19], v[130:131], v[78:79], v[18:19] op_sel_hi:[1,0,1]
    v_pk_fma_f32 v[20:21], v[132:133], v[94:95], v[20:21] op_sel_hi:[1,0,1]
    v_pk_fma_f32 v[22:23], v[134:135], v[94:95], v[22:23] op_sel_hi:[1,0,1]
    s_set_gpr_idx_idx s71
    s_nop 0
    v_pk_fma_f32 v[16:17], v[136:137], v[78:79], v[16:17] op_sel:[0,1,0] op_sel_hi:[1,1,1]
    v_pk_fma_f32 v[18:19], v[138:139], v[78:79], v[18:19] op_sel:[0,1,0] op_sel_hi:[1,1,1]
    v_pk_fma_f32 v[20:21], v[140:141], v[94:95], v[20:21] op_sel:[0,1,0] op_sel_hi:[1,1,1]
    v_pk_fma_f32 v[22:23], v[142:143], v[94:95], v[22:23] op_sel:[0,1,0] op_sel_hi:[1,1,1]
    ds_read_b128 v[120:123], v215 offset:12288
    ds_read_b128 v[124:127], v215 offset:13312
    s_set_gpr_idx_off
L_swept:
    s_add_u32 s48, s48, 224
    s_cmp_lt_u32 s48, s47
    s_cbranch_scc1 L_again
    s_setprio 0
    v_cvt_pk_bf16_f32 v64, v16, v20
    v_cvt_pk_bf16_f32 v65, v17, v21
    v_cvt_pk_bf16_f32 v66, v18, v22
    v_cvt_pk_bf16_f32 v67, v19, v23
    ds_write2_b32 v208, v64, v65 offset0:0 offset1:72
    ds_write2_b32 v208, v66, v67 offset0:144 offset1:216
    v_cvt_pk_bf16_f32 v68, v24, v28
    v_cvt_pk_bf16_f32 v69, v25, v29
    v_cvt_pk_bf16_f32 v70, v26, v30
    v_cvt_pk_bf16_f32 v71, v27, v31
    ds_write2_b32 v209, v68, v69 offset0:0 offset1:72
    ds_write2_b32 v209, v70, v71 offset0:144 offset1:216
    v_cvt_pk_bf16_f32 v72, v32, v36
    v_cvt_pk_bf16_f32 v73, v33, v37
    v_cvt_pk_bf16_f32 v74, v34, v38
    v_cvt_pk_bf16_f32 v75, v35, v39
    ds_write2_b32 v210, v72, v73 offset0:0 offset1:72
    ds_write2_b32 v210, v74, v75 offset0:144 offset1:216
    v_cvt_pk_bf16_f32 v76, v40, v44
    v_cvt_pk_bf16_f32 v77, v41, v45
    v_cvt_pk_bf16_f32 v78, v42, v46
    v_cvt_pk_bf16_f32 v79, v43, v47
    ds_write2_b32 v211, v76, v77 offset0:0 offset1:72
    ds_write2_b32 v211, v78, v79 offset0:144 offset1:216
    v_cvt_pk_bf16_f32 v80, v48, v52
    v_cvt_pk_bf16_f32 v81, v49, v53
    v_cvt_pk_bf16_f32 v82, v50, v54
    v_cvt_pk_bf16_f32 v83, v51, v55
    ds_write2_b32 v212, v80, v81 offset0:0 offset1:72
    ds_write2_b32 v212, v82, v83 offset0:144 offset1:216
    s_waitcnt lgkmcnt(0)
    s_barrier
    ds_read_b128 v[16:19], v213 offset:0
    ds_read_b128 v[20:23], v213 offset:64
    ds_read_b128 v[24:27], v213 offset:128
    ds_read_b128 v[28:31], v213 offset:192
    s_waitcnt lgkmcnt(3)
    v_mfma_f32_16x16x32_bf16 v[160:163], v[16:19], v[216:219], 0
    v_mfma_f32_16x16x32_bf16 v[164:167], v[16:19], v[220:223], 0
    v_mfma_f32_16x16x32_bf16 v[168:171], v[16:19], v[224:227], 0
    v_mfma_f32_16x16x32_bf16 v[172:175], v[16:19], v[228:231], 0
    ds_read_b128 v[32:35], v213 offset:4608
    ds_read_b128 v[36:39], v213 offset:4672
    ds_read_b128 v[40:43], v213 offset:4736
    ds_read_b128 v[44:47], v213 offset:4800
    s_waitcnt lgkmcnt(6)
    v_mfma_f32_16x16x32_bf16 v[160:163], v[20:23], v[232:235], v[160:163]
    v_mfma_f32_16x16x32_bf16 v[164:167], v[20:23], v[236:239], v[164:167]
    v_mfma_f32_16x16x32_bf16 v[168:171], v[20:23], v[96:99], v[168:171]
    v_mfma_f32_16x16x32_bf16 v[172:175], v[20:23], v[100:103], v[172:175]
    ds_read_b128 v[48:51], v213 offset:9216
    ds_read_b128 v[52:55], v213 offset:9280
    ds_read_b128 v[56:59], v213 offset:9344
    ds_read_b128 v[60:63], v213 offset:9408
    s_waitcnt lgkmcnt(9)
    v_mfma_f32_16x16x32_bf16 v[160:163], v[24:27], v[104:107], v[160:163]
    v_mfma_f32_16x16x32_bf16 v[164:167], v[24:27], v[108:111], v[164:167]
    v_mfma_f32_16x16x32_bf16 v[168:171], v[24:27], v[112:115], v[168:171]
    v_mfma_f32_16x16x32_bf16 v[172:175], v[24:27], v[116:119], v[172:175]
    s_waitcnt lgkmcnt(8)
    v_mfma_f32_16x16x32_bf16 v[160:163], v[28:31], v[120:123], v[160:163]
    v_mfma_f32_16x16x32_bf16 v[164:167], v[28:31], v[124:127], v[164:167]
    v_mfma_f32_16x16x32_bf16 v[168:171], v[28:31], v[144:147], v[168:171]
    v_mfma_f32_16x16x32_bf16 v[172:175], v[28:31], v[148:151], v[172:175]
    s_waitcnt lgkmcnt(4)
    v_mfma_f32_16x16x32_bf16 v[176:179], v[32:35], v[216:219], 0
    v_mfma_f32_16x16x32_bf16 v[180:183], v[32:35], v[220:223], 0
    v_mfma_f32_16x16x32_bf16 v[184:187], v[32:35], v[224:227], 0
    v_mfma_f32_16x16x32_bf16 v[188:191], v[32:35], v[228:231], 0
    v_mfma_f32_16x16x32_bf16 v[176:179], v[36:39], v[232:235], v[176:179]
    v_cvt_pk_bf16_f32 v64, v160, v164
    v_cvt_pk_bf16_f32 v80, v160, v164
    v_mfma_f32_16x16x32_bf16 v[180:183], v[36:39], v[236:239], v[180:183]
    v_cvt_pk_bf16_f32 v66, v162, v166
    v_cvt_pk_bf16_f32 v65, v168, v172
    v_mfma_f32_16x16x32_bf16 v[184:187], v[36:39], v[96:99], v[184:187]
    v_cvt_pk_bf16_f32 v81, v168, v172
    v_cvt_pk_bf16_f32 v67, v170, v174
    v_mfma_f32_16x16x32_bf16 v[188:191], v[36:39], v[100:103], v[188:191]
    v_mov_b32_dpp v64, v66 row_ror:8 row_mask:0xf bank_mask:0xc
    v_mov_b32_dpp v65, v67 row_ror:8 row_mask:0xf bank_mask:0xc
    v_mfma_f32_16x16x32_bf16 v[176:179], v[40:43], v[104:107], v[176:179]
    v_mov_b32_dpp v66, v80 row_ror:8 row_mask:0xf bank_mask:0x3
    v_mov_b32_dpp v67, v81 row_ror:8 row_mask:0xf bank_mask:0x3
    v_mfma_f32_16x16x32_bf16 v[180:183], v[40:43], v[108:111], v[180:183]
    buffer_store_dwordx4 v[64:67], v214, s[40:43], s87 offen offset:0 sc1
    v_cvt_pk_bf16_f32 v68, v161, v165
    v_mfma_f32_16x16x32_bf16 v[184:187], v[40:43], v[112:115], v[184:187]
    v_cvt_pk_bf16_f32 v82, v161, v165
    v_cvt_pk_bf16_f32 v70, v163, v167
    v_mfma_f32_16x16x32_bf16 v[188:191], v[40:43], v[116:119], v[188:191]
    v_cvt_pk_bf16_f32 v69, v169, v173
    v_cvt_pk_bf16_f32 v83, v169, v173
    v_mfma_f32_16x16x32_bf16 v[176:179], v[44:47], v[120:123], v[176:179]
    v_cvt_pk_bf16_f32 v71, v171, v175
    v_mov_b32_dpp v68, v70 row_ror:8 row_mask:0xf bank_mask:0xc
    v_mfma_f32_16x16x32_bf16 v[180:183], v[44:47], v[124:127], v[180:183]
    v_mov_b32_dpp v69, v71 row_ror:8 row_mask:0xf bank_mask:0xc
    v_mov_b32_dpp v70, v82 row_ror:8 row_mask:0xf bank_mask:0x3
    v_mfma_f32_16x16x32_bf16 v[184:187], v[44:47], v[144:147], v[184:187]
    v_mov_b32_dpp v71, v83 row_ror:8 row_mask:0xf bank_mask:0x3
    buffer_store_dwordx4 v[68:71], v214, s[40:43], s87 offen offset:256 sc1
    v_mfma_f32_16x16x32_bf16 v[188:191], v[44:47], v[148:151], v[188:191]
    s_add_u32 s87, s87, 4096
    s_cmp_ge_u32 s3, 4
    s_cbranch_scc1 L_two
    s_waitcnt lgkmcnt(0)
    v_mfma_f32_16x16x32_bf16 v[160:163], v[48:51], v[216:219], 0
    v_mfma_f32_16x16x32_bf16 v[164:167], v[48:51], v[220:223], 0
    v_mfma_f32_16x16x32_bf16 v[168:171], v[48:51], v[224:227], 0
    v_mfma_f32_16x16x32_bf16 v[172:175], v[48:51], v[228:231], 0
    v_mfma_f32_16x16x32_bf16 v[160:163], v[52:55], v[232:235], v[160:163]
    v_cvt_pk_bf16_f32 v72, v176, v180
    v_cvt_pk_bf16_f32 v80, v176, v180
    v_mfma_f32_16x16x32_bf16 v[164:167], v[52:55], v[236:239], v[164:167]
    v_cvt_pk_bf16_f32 v74, v178, v182
    v_cvt_pk_bf16_f32 v73, v184, v188
    v_mfma_f32_16x16x32_bf16 v[168:171], v[52:55], v[96:99], v[168:171]
    v_cvt_pk_bf16_f32 v81, v184, v188
    v_cvt_pk_bf16_f32 v75, v186, v190
    v_mfma_f32_16x16x32_bf16 v[172:175], v[52:55], v[100:103], v[172:175]
    v_mov_b32_dpp v72, v74 row_ror:8 row_mask:0xf bank_mask:0xc
    v_mov_b32_dpp v73, v75 row_ror:8 row_mask:0xf bank_mask:0xc
    v_mfma_f32_16x16x32_bf16 v[160:163], v[56:59], v[104:107], v[160:163]
    v_mov_b32_dpp v74, v80 row_ror:8 row_mask:0xf bank_mask:0x3
    v_mov_b32_dpp v75, v81 row_ror:8 row_mask:0xf bank_mask:0x3
    v_mfma_f32_16x16x32_bf16 v[164:167], v[56:59], v[108:111], v[164:167]
    buffer_store_dwordx4 v[72:75], v214, s[40:43], s87 offen offset:0 sc1
    v_cvt_pk_bf16_f32 v76, v177, v181
    v_mfma_f32_16x16x32_bf16 v[168:171], v[56:59], v[112:115], v[168:171]
    v_cvt_pk_bf16_f32 v82, v177, v181
    v_cvt_pk_bf16_f32 v78, v179, v183
    v_mfma_f32_16x16x32_bf16 v[172:175], v[56:59], v[116:119], v[172:175]
    v_cvt_pk_bf16_f32 v77, v185, v189
    v_cvt_pk_bf16_f32 v83, v185, v189
    v_mfma_f32_16x16x32_bf16 v[160:163], v[60:63], v[120:123], v[160:163]
    v_cvt_pk_bf16_f32 v79, v187, v191
    v_mov_b32_dpp v76, v78 row_ror:8 row_mask:0xf bank_mask:0xc
    v_mfma_f32_16x16x32_bf16 v[164:167], v[60:63], v[124:127], v[164:167]
    v_mov_b32_dpp v77, v79 row_ror:8 row_mask:0xf bank_mask:0xc
    v_mov_b32_dpp v78, v82 row_ror:8 row_mask:0xf bank_mask:0x3
    v_mfma_f32_16x16x32_bf16 v[168:171], v[60:63], v[144:147], v[168:171]
    v_mov_b32_dpp v79, v83 row_ror:8 row_mask:0xf bank_mask:0x3
    buffer_store_dwordx4 v[76:79], v214, s[40:43], s87 offen offset:256 sc1
    v_mfma_f32_16x16x32_bf16 v[172:175], v[60:63], v[148:151], v[172:175]
    s_add_u32 s87, s87, 4096
    s_nop 0
    v_cvt_pk_bf16_f32 v64, v160, v164
    v_cvt_pk_bf16_f32 v80, v160, v164
    v_cvt_pk_bf16_f32 v66, v162, v166
    s_nop 2
    v_cvt_pk_bf16_f32 v65, v168, v172
    v_cvt_pk_bf16_f32 v81, v168, v172
    v_cvt_pk_bf16_f32 v67, v170, v174
    v_mov_b32_dpp v64, v66 row_ror:8 row_mask:0xf bank_mask:0xc
    s_nop 0
    v_mov_b32_dpp v65, v67 row_ror:8 row_mask:0xf bank_mask:0xc
    v_mov_b32_dpp v66, v80 row_ror:8 row_mask:0xf bank_mask:0x3
    v_mov_b32_dpp v67, v81 row_ror:8 row_mask:0xf bank_mask:0x3
    buffer_store_dwordx4 v[64:67], v214, s[40:43], s87 offen offset:0 sc1
    v_cvt_pk_bf16_f32 v68, v161, v165
    v_cvt_pk_bf16_f32 v82, v161, v165
    v_cvt_pk_bf16_f32 v70, v163, v167
    v_cvt_pk_bf16_f32 v69, v169, v173
    v_cvt_pk_bf16_f32 v83, v169, v173
    v_cvt_pk_bf16_f32 v71, v171, v175
    v_mov_b32_dpp v68, v70 row_ror:8 row_mask:0xf bank_mask:0xc
    s_nop 0
    v_mov_b32_dpp v69, v71 row_ror:8 row_mask:0xf bank_mask:0xc
    v_mov_b32_dpp v70, v82 row_ror:8 row_mask:0xf bank_mask:0x3
    v_mov_b32_dpp v71, v83 row_ror:8 row_mask:0xf bank_mask:0x3
    buffer_store_dwordx4 v[68:71], v214, s[40:43], s87 offen offset:256 sc1
    s_add_u32 s87, s87, 4096
L_stored:
L_done:
    s_endpgm
L_again:
    s_waitcnt vmcnt(0) lgkmcnt(0)
    s_barrier
    v_lshlrev_b32 v11, 2, v0
    v_mov_b32 v12, 0x00700000
    v_mov_b32 v13, 0
    ds_write_b32 v11, v12 offset:0
    ds_write_b32 v11, v12 offset:2048
    ds_write_b32 v11, v12 offset:4096
    ds_write_b32 v11, v12 offset:6144
    ds_write_b32 v11, v13 offset:8192
    ds_write_b32 v11, v13 offset:10240
    ds_write_b32 v11, v13 offset:12288
    v_mov_b32 v64, 0
    v_mov_b32 v65, 0
    v_mov_b32 v66, 0
    v_mov_b32 v67, 0
    v_mov_b32 v68, 0
    v_mov_b32 v69, 0
    v_mov_b32 v70, 0
    v_mov_b32 v71, 0
    v_mov_b32 v72, 0
    v_mov_b32 v73, 0
    v_mov_b32 v74, 0
    v_mov_b32 v75, 0
    v_mov_b32 v76, 0
    v_mov_b32 v77, 0
    v_mov_b32 v78, 0
    v_mov_b32 v79, 0
    v_mov_b32 v80, 0
    v_mov_b32 v81, 0
    v_mov_b32 v82, 0
    v_mov_b32 v83, 0
    v_mov_b32 v84, 0
    v_mov_b32 v85, 0
    v_mov_b32 v86, 0
    v_mov_b32 v87, 0
    v_mov_b32 v88, 0
    v_mov_b32 v89, 0
    v_mov_b32 v90, 0
    v_mov_b32 v91, 0
    v_mov_b32 v92, 0
    v_mov_b32 v93, 0
    v_mov_b32 v94, 0
    v_mov_b32 v95, 0
    v_add_u32 v3, v3, v4
    v_subrev_u32 v3, 224, v3
    v_max_i32 v3, 0, v3
    v_subrev_u32 v4, 224, v4
    v_max_i32 v4, 0, v4
    v_sub_u32 v3, v3, v4
    v_add_u32 v5, 224, v5
    s_sub_i32 s95, s95, 224
    v_lshl_add_u32 v8, v4, 2, v241
    s_waitcnt lgkmcnt(0)
    s_barrier
L_clip:
    v_add_u32 v10, v4, v3
    v_min_i32 v10, 224, v10
    v_sub_u32 v10, v10, v4
    v_add_u32 v10, v10, v240
L_masks:
    v_cmp_lt_i32 s[64:65], 0, v10
    v_cmp_lt_i32 s[66:67], 2, v10
    v_cmp_lt_i32 s[68:69], 4, v10
    v_cmp_lt_i32 s[70:71], 6, v10
    v_cmp_lt_i32 s[72:73], 8, v10
    v_cmp_lt_i32 s[74:75], 10, v10
    v_cmp_lt_i32 s[76:77], 12, v10
    v_cmp_lt_i32 s[78:79], 14, v10
    s_nop 0
    s_branch L_mapw
L_map2:
    v_add_u32 v8, 56, v8
    v_subrev_u32 v10, 14, v10
    s_branch L_masks
L_r1:
    ds_read_b32 v139, v242 offset:768
    ds_read_b32 v146, v243 offset:768
    s_waitcnt lgkmcnt(0)
    v_mad_u32_u24 v139, v139, 12, v244
    buffer_load_dwordx3 v[160:162], v139, s[24:27], 0 offen offset:2304 sc1
    v_lshl_add_u32 v146, v146, 5, v2
    s_add_u32 m0, s52, 4096
    s_nop 0
    buffer_load_dwordx4 v146, s[28:31], s98 offen offset:2048 sc1 lds
    s_branch L_r1b
L_r2:
    v_lshrrev_b32 v135, 21, v162
    v_lshlrev_b32 v135, 2, v135
    v_lshrrev_b32 v11, 26, v162
    v_lshl_or_b32 v11, v11, 4, v245
    s_mov_b64 exec, s[96:97]
    ds_add_rtn_u32 v131, v135, v6 offset:8192
    ds_add_u32 v11, v6 offset:14336
    s_mov_b64 exec, -1
    s_mov_b32 exec_hi, 0
    ds_write_b64 v246, v[160:161] offset:1536
    s_mov_b32 exec_hi, -1
    v_and_or_b32 v162, v162, s55, v247
    v_add_u32 v162, 402653184, v162
    s_branch L_r2b
L_r3:
    ds_read_b32 v135, v135 offset:8192
    s_waitcnt lgkmcnt(0)
    v_bfe_u32 v15, v135, 12, 3
    v_or_b32 v162, v15, v162
    v_and_b32 v139, 0x3ff, v135
    v_lshrrev_b32 v135, 16, v135
    v_add_u32 v135, v135, v131
    ds_read_b32 v139, v139 offset:16384
    s_waitcnt lgkmcnt(0)
    v_lshl_add_u32 v135, v135, 2, v139
    s_mov_b64 exec, s[96:97]
    ds_write_b32 v135, v162
    s_mov_b64 exec, -1
    s_branch L_r3b
L_tag:
    v_mov_b32 v11, s62
    s_mov_b32 s54, 524288
    buffer_store_dword v11, v242, s[20:23], s54 offen sc1
    s_branch L_tagged
L_empty:
    s_waitcnt vmcnt(0) lgkmcnt(0)
    s_barrier
    v_lshlrev_b32 v12, 2, v1
    s_lshl_b32 s61, s3, 7
    v_and_b32 v205, 0x7380, v205
    v_xor_b32 v205, s61, v205
    v_alignbit_b32 v205, v205, v205, 12
    v_cmp_eq_u32 s[80:81], 0, v205
    v_cmp_eq_u32 s[82:83], 1, v205
    v_cmp_eq_u32 s[84:85], 2, v205
    v_cmp_eq_u32 s[96:97], 3, v205
    v_cmp_eq_u32 vcc, 4, v205
    s_ff1_i32_b64 s56, s[80:81]
    s_mul_i32 s56, s56, 1152
    v_add_u32 v208, s56, v12
    s_ff1_i32_b64 s57, s[82:83]
    s_mul_i32 s57, s57, 1152
    v_add_u32 v209, s57, v12
    s_ff1_i32_b64 s58, s[84:85]
    s_mul_i32 s58, s58, 1152
    v_add_u32 v210, s58, v12
    s_ff1_i32_b64 s59, s[96:97]
    s_mul_i32 s59, s59, 1152
    v_add_u32 v211, s59, v12
    s_ff1_i32_b64 s60, vcc
    s_mul_i32 s60, s60, 1152
    v_add_u32 v212, s60, v12
    ds_read_b128 v[96:99], v215 offset:6144
    ds_read_b128 v[100:103], v215 offset:7168
    ds_read_b128 v[104:107], v215 offset:8192
    ds_read_b128 v[108:111], v215 offset:9216
    ds_read_b128 v[112:115], v215 offset:10240
    ds_read_b128 v[116:119], v215 offset:11264
    ds_read_b128 v[120:123], v215 offset:12288
    ds_read_b128 v[124:127], v215 offset:13312
    ds_read_b128 v[144:147], v215 offset:14336
    ds_read_b128 v[148:151], v215 offset:15360
    s_branch L_swept
L_two:
    s_nop 7
    v_cvt_pk_bf16_f32 v72, v176, v180
    v_cvt_pk_bf16_f32 v80, v176, v180
    v_cvt_pk_bf16_f32 v74, v178, v182
    v_cvt_pk_bf16_f32 v73, v184, v188
    v_cvt_pk_bf16_f32 v81, v184, v188
    v_cvt_pk_bf16_f32 v75, v186, v190
    v_mov_b32_dpp v72, v74 row_ror:8 row_mask:0xf bank_mask:0xc
    s_nop 0
    v_mov_b32_dpp v73, v75 row_ror:8 row_mask:0xf bank_mask:0xc
    v_mov_b32_dpp v74, v80 row_ror:8 row_mask:0xf bank_mask:0x3
    v_mov_b32_dpp v75, v81 row_ror:8 row_mask:0xf bank_mask:0x3
    buffer_store_dwordx4 v[72:75], v214, s[40:43], s87 offen offset:0 sc1
    v_cvt_pk_bf16_f32 v76, v177, v181
    v_cvt_pk_bf16_f32 v82, v177, v181
    v_cvt_pk_bf16_f32 v78, v179, v183
    v_cvt_pk_bf16_f32 v77, v185, v189
    v_cvt_pk_bf16_f32 v83, v185, v189
    v_cvt_pk_bf16_f32 v79, v187, v191
    v_mov_b32_dpp v76, v78 row_ror:8 row_mask:0xf bank_mask:0xc
    s_nop 0
    v_mov_b32_dpp v77, v79 row_ror:8 row_mask:0xf bank_mask:0xc
    v_mov_b32_dpp v78, v82 row_ror:8 row_mask:0xf bank_mask:0x3
    v_mov_b32_dpp v79, v83 row_ror:8 row_mask:0xf bank_mask:0x3
    buffer_store_dwordx4 v[76:79], v214, s[40:43], s87 offen offset:256 sc1
    s_add_u32 s87, s87, 4096
    s_branch L_stored
L_poll:
    buffer_load_dwordx2 v[206:207], v10, s[20:23], s49 offen sc1
    s_sub_u32 s53, s53, 1
    s_cbranch_scc1 L_done
    s_waitcnt vmcnt(0)
    v_xor_b32 v11, s63, v206
    v_xor_b32 v12, s62, v207
    v_and_or_b32 v11, v11, s55, v12
    v_cmpx_ne_u32 vcc, 0, v11
    s_cbranch_execnz L_poll
    s_branch L_polled
L_rank2:
    ds_read_b32 v96, v248 offset:8192
    ds_read_b32 v97, v248 offset:8320
    ds_read_b32 v98, v248 offset:8448
    ds_read_b32 v99, v248 offset:8576
    ds_read_b32 v100, v248 offset:8704
    ds_write_b64 v246, v[148:149] offset:0
    v_and_or_b32 v150, v150, s55, v247
    ds_write_b64 v246, v[152:153] offset:512
    v_and_or_b32 v154, v154, s55, v247
    v_add_u32 v154, 134217728, v154
    ds_write_b64 v246, v[156:157] offset:1024
    v_and_or_b32 v158, v158, s55, v247
    v_add_u32 v158, 268435456, v158
    s_waitcnt lgkmcnt(0)
L_end:
    s_branch L_ranked
.section .rodata,"a"
.p2align 6
.amdhsa_kernel gather_scatter__tensor_product_equiv_mace__graph_kernel
  .amdhsa_next_free_vgpr 256
  .amdhsa_next_free_sgpr 102
  .amdhsa_accum_offset 256
  .amdhsa_group_segment_fixed_size 0
  .amdhsa_kernarg_size 88
  .amdhsa_user_sgpr_count 2
  .amdhsa_user_sgpr_kernarg_segment_ptr 1
  .amdhsa_system_sgpr_workgroup_id_x 1
  .amdhsa_float_denorm_mode_32 3
.end_amdhsa_kernel
```

```asm
; @launch grid=(256,1,1) block=(512,1,1) lds=158784
.amdgcn_target "amdgcn-amd-amdhsa--gfx950"
.text
.globl gather_scatter__tensor_product_equiv_mace__graph_kernel
.p2align 8
.type gather_scatter__tensor_product_equiv_mace__graph_kernel,@function
gather_scatter__tensor_product_equiv_mace__graph_kernel:
    s_cmp_ge_u32 s2, 256
    s_cbranch_scc1 L_done
    s_load_dwordx4 s[4:7], s[0:1], 8
    s_load_dwordx4 s[8:11], s[0:1], 24
    s_load_dwordx2 s[14:15], s[0:1], 80
    s_load_dwordx2 s[64:65], s[0:1], 0
    s_load_dwordx2 s[66:67], s[0:1], 40
    s_load_dwordx4 s[68:71], s[0:1], 48
    s_load_dwordx2 s[12:13], s[0:1], 64
    v_lshlrev_b32 v10, 3, v0
    s_getpc_b64 s[80:81]
L_pc:
    s_and_b32 s44, s2, 0xf8
    s_lshl_b32 s44, s44, 6
    v_and_b32 v11, 0x180, v10
    v_add_u32 v11, s44, v11
    v_min_u32 v11, L_end-L_pc, v11
    v_mov_b32 v113, s81
    v_add_co_u32 v112, vcc, s80, v11
    s_nop 1
    v_addc_co_u32 v113, vcc, 0, v113, vcc
    global_load_dword v205, v[112:113], off
    v_lshrrev_b32 v8, 6, v0
    v_and_b32 v1, 63, v0
    v_lshlrev_b32 v9, 2, v0
    v_mov_b32 v13, 0
    v_readfirstlane_b32 s3, v8
    ds_write_b32 v9, v13 offset:23552
    ds_write_b32 v9, v13 offset:28672
    s_mul_i32 s54, s2, 5000
    s_mul_i32 s55, s2, 10000
    s_mul_i32 s61, s2, 40000
    v_lshlrev_b32 v2, 4, v1
    v_lshlrev_b32 v15, 4, v0
    v_mov_b32 v6, 1
    s_lshl_b32 s52, s3, 10
    s_add_u32 s52, s52, 101376
    s_movk_i32 s53, 4096
    s_movk_i32 s50, 8192
    s_mov_b32 s34, 5000
    s_mov_b32 s35, 0x20000
    s_mov_b32 s38, 5000
    s_mov_b32 s39, 0x20000
    s_mov_b32 s98, 10000
    s_mov_b32 s99, 0x20000
    s_mov_b32 s30, 40000
    s_mov_b32 s31, 0x20000
    s_waitcnt lgkmcnt(0)
    s_add_u32 s32, s6, s54
    s_addc_u32 s33, s7, 0
    buffer_load_dword v64, v9, s[32:35], 0 offen offset:0 nt
    buffer_load_dword v65, v9, s[32:35], 0 offen offset:2048 nt
    buffer_load_dword v66, v9, s[32:35], s53 offen nt
    s_add_u32 s36, s4, s54
    s_addc_u32 s37, s5, 0
    s_barrier
    buffer_load_dword v68, v9, s[36:39], 0 offen offset:0 nt
    buffer_load_dword v69, v9, s[36:39], 0 offen offset:2048 nt
    buffer_load_dword v70, v9, s[36:39], s53 offen nt
    s_load_dword s62, s[14:15], 786432
    s_add_u32 s96, s8, s55
    s_addc_u32 s97, s9, 0
    s_add_u32 s28, s10, s61
    s_addc_u32 s29, s11, 0
    buffer_load_dwordx2 v[72:73], v10, s[96:99], 0 offen nt
    buffer_load_dwordx2 v[74:75], v10, s[96:99], s53 offen nt
    buffer_load_dwordx2 v[76:77], v10, s[96:99], s50 offen nt
    s_add_u32 m0, s52, 0
    s_mov_b32 s54, 0
    buffer_load_dwordx4 v15, s[28:31], s54 offen nt lds
    s_add_u32 m0, s52, 8192
    s_mov_b32 s54, 8192
    buffer_load_dwordx4 v15, s[28:31], s54 offen nt lds
    s_add_u32 m0, s52, 16384
    s_mov_b32 s54, 16384
    buffer_load_dwordx4 v15, s[28:31], s54 offen nt lds
    s_mov_b32 s72, 109951168
    s_movk_i32 s73, 625
    s_movk_i32 s74, 838
    s_movk_i32 s54, 226
    v_cmp_gt_u32 s[84:85], s54, v0
    s_mov_b32 s20, s14
    s_mov_b32 s21, s15
    s_mov_b32 s22, 786496
    s_mov_b32 s23, 0x20000
    v_lshlrev_b32 v11, 2, v0
    v_mov_b32 v12, 0x00700000
    v_mov_b32 v13, 0
    ds_write_b32 v11, v12 offset:0
    ds_write_b32 v11, v12 offset:2048
    ds_write_b32 v11, v12 offset:4096
    ds_write_b32 v11, v12 offset:6144
    ds_write_b32 v11, v13 offset:8192
    ds_write_b32 v11, v13 offset:10240
    ds_write_b32 v11, v13 offset:12288
    ds_write_b32 v11, v13 offset:14336
    s_waitcnt vmcnt(9)
    v_mul_hi_u32 v80, v64, s72
    v_mul_hi_u32 v81, v65, s72
    v_mul_hi_u32 v82, v66, s72
    v_lshlrev_b32 v84, 2, v80
    ds_add_rtn_u32 v88, v84, v6 offset:23552
    v_lshlrev_b32 v85, 2, v81
    ds_add_rtn_u32 v89, v85, v6 offset:23552
    v_lshlrev_b32 v86, 2, v82
    s_mov_b64 exec, s[84:85]
    ds_add_rtn_u32 v90, v86, v6 offset:23552
    s_mov_b64 exec, -1
    s_waitcnt lgkmcnt(0)
    s_barrier
    ds_read_b128 v[100:103], v2 offset:23552
    s_mul_i32 s62, s62, 0x9e3779b1
    s_add_u32 s62, s62, 0x7f4a7c15
    s_mul_i32 s63, s62, 0x85ebca6b
    s_and_b32 s63, s63, 0xffc00000
    s_add_u32 m0, s52, 24576
    s_mov_b32 s54, 24576
    buffer_load_dwordx4 v15, s[28:31], s54 offen nt lds
    s_add_u32 m0, s52, 32768
    s_mov_b32 s54, 32768
    buffer_load_dwordx4 v15, s[28:31], s54 offen nt lds
    v_mad_u32_u24 v92, v80, s73, 15
    v_lshrrev_b32 v92, 4, v92
    v_sub_u32 v92, v64, v92
    v_mad_u32_u24 v93, v81, s73, 15
    v_lshrrev_b32 v93, 4, v93
    v_sub_u32 v93, v65, v93
    v_mad_u32_u24 v94, v82, s73, 15
    v_lshrrev_b32 v94, 4, v94
    v_sub_u32 v94, v66, v94
    s_waitcnt lgkmcnt(0)
    v_add_u32 v11, v100, v101
    v_add3_u32 v11, v11, v102, v103
    v_mov_b32 v12, v11
    s_nop 1
    v_add_u32_dpp v12, v12, v12 row_shr:1 row_mask:0xf bank_mask:0xf
    s_nop 1
    v_add_u32_dpp v12, v12, v12 row_shr:2 row_mask:0xf bank_mask:0xf
    s_nop 1
    v_add_u32_dpp v12, v12, v12 row_shr:4 row_mask:0xf bank_mask:0xf
    s_nop 1
    v_add_u32_dpp v12, v12, v12 row_shr:8 row_mask:0xf bank_mask:0xf
    s_nop 1
    v_add_u32_dpp v12, v12, v12 row_bcast:15 row_mask:0xa bank_mask:0xf
    s_nop 1
    v_add_u32_dpp v12, v12, v12 row_bcast:31 row_mask:0xc bank_mask:0xf
    v_sub_u32 v104, v12, v11
    v_add_u32 v105, v104, v100
    v_add_u32 v106, v105, v101
    v_add_u32 v107, v106, v102
    ds_write_b128 v2, v[104:107] offset:24576
    ds_read_b32 v108, v84 offset:24576
    ds_read_b32 v109, v85 offset:24576
    ds_read_b32 v110, v86 offset:24576
    s_waitcnt vmcnt(8)
    v_mul_u32_u24 v96, s74, v68
    v_bfe_u32 v96, v96, 18, 5
    v_lshl_or_b32 v96, v92, 5, v96
    v_lshlrev_b32 v96, 21, v96
    v_lshl_or_b32 v96, v68, 7, v96
    v_mul_u32_u24 v97, s74, v69
    v_bfe_u32 v97, v97, 18, 5
    v_lshl_or_b32 v97, v93, 5, v97
    v_lshlrev_b32 v97, 21, v97
    v_lshl_or_b32 v97, v69, 7, v97
    v_mul_u32_u24 v98, s74, v70
    v_bfe_u32 v98, v98, 18, 5
    v_lshl_or_b32 v98, v94, 5, v98
    v_lshlrev_b32 v98, 21, v98
    v_lshl_or_b32 v98, v70, 7, v98
    v_lshlrev_b32 v92, 5, v0
    v_add_u32 v93, 16384, v92
    v_add_u32 v94, 32768, v92
    s_mov_b32 s55, 30720
    s_waitcnt vmcnt(5) lgkmcnt(0)
    v_add_u32 v108, v108, v88
    v_lshlrev_b32 v84, 2, v108
    v_mad_u32_u24 v108, v108, 12, s55
    ds_write_b32 v84, v92 offset:25600
    ds_write2_b32 v108, v72, v73 offset0:0 offset1:1
    ds_write_b32 v108, v96 offset:8
    v_add_u32 v109, v109, v89
    v_lshlrev_b32 v85, 2, v109
    v_mad_u32_u24 v109, v109, 12, s55
    ds_write_b32 v85, v93 offset:25600
    ds_write2_b32 v109, v74, v75 offset0:0 offset1:1
    ds_write_b32 v109, v97 offset:8
    v_add_u32 v110, v110, v90
    v_lshlrev_b32 v86, 2, v110
    v_mad_u32_u24 v110, v110, 12, s55
    s_mov_b64 exec, s[84:85]
    ds_write_b32 v86, v94 offset:25600
    ds_write2_b32 v110, v76, v77 offset0:0 offset1:1
    ds_write_b32 v110, v98 offset:8
    s_mov_b64 exec, -1
    s_lshl_b32 s54, s3, 7
    v_lshl_add_u32 v11, v1, 3, s54
    ds_read_b64 v[100:101], v11 offset:23552
    ds_read_b64 v[104:105], v11 offset:24576
    s_mul_i32 s54, s2, 15360
    s_add_u32 s54, s54, 1048576
    s_add_u32 s32, s14, s54
    s_addc_u32 s33, s15, 0
    s_mov_b32 s34, 15360
    s_mov_b32 s35, 0x20000
    s_mul_i32 s54, s2, 40960
    s_add_u32 s54, s54, 5767168
    s_add_u32 s36, s14, s54
    s_addc_u32 s37, s15, 0
    s_mov_b32 s38, 40064
    s_mov_b32 s39, 0x20000
    v_lshrrev_b32 v11, 1, v0
    v_lshlrev_b32 v11, 2, v11
    v_and_b32 v12, 1, v0
    v_lshlrev_b32 v12, 4, v12
    v_add_u32 v12, 101376, v12
    v_add_u32 v14, 30720, v15
    s_waitcnt lgkmcnt(0)
    s_barrier
    ds_read_b128 v[128:131], v14
    ds_read_b128 v[132:135], v14 offset:8192
    ds_read_b32 v156, v11 offset:25600
    ds_read_b32 v157, v11 offset:26624
    ds_read_b32 v158, v11 offset:27648
    ds_read_b32 v159, v11 offset:28672
    ds_read_b32 v160, v11 offset:29696
    s_cmp_lt_u32 s3, 4
    s_cselect_b32 s16, s68, s66
    s_cselect_b32 s17, s69, s67
    s_movk_i32 s54, 128
    s_cselect_b32 s18, s53, s54
    s_mov_b32 s19, 0x20000
    s_min_u32 s54, s3, 5
    s_lshl_b32 s54, s54, 10
    s_add_u32 m0, s54, 17408
    s_and_b32 s54, s54, 0xc00
    buffer_load_dwordx4 v2, s[16:19], s54 offen lds
    s_mov_b32 s40, s70
    s_mov_b32 s41, s71
    s_mov_b32 s42, 32768
    s_mov_b32 s43, 0x20000
    s_lshl_b32 s55, s3, 12
    s_add_u32 m0, s55, 46080
    s_nop 0
    buffer_load_dwordx4 v2, s[40:43], s55 offen offset:0 lds
    buffer_load_dwordx4 v2, s[40:43], s55 offen offset:1024 lds
    buffer_load_dwordx4 v2, s[40:43], s55 offen offset:2048 lds
    buffer_load_dwordx4 v2, s[40:43], s55 offen offset:3072 lds
    s_waitcnt lgkmcnt(0)
    v_add_u32 v156, v12, v156
    v_add_u32 v157, v12, v157
    v_add_u32 v158, v12, v158
    v_add_u32 v159, v12, v159
    v_add_u32 v160, v12, v160
    v_lshl_or_b32 v112, v100, 11, v104
    v_or_b32 v112, s63, v112
    v_mov_b32 v113, s62
    v_lshl_or_b32 v114, v101, 11, v105
    v_or_b32 v114, s63, v114
    v_mov_b32 v115, s62
    s_waitcnt vmcnt(0)
    s_barrier
    ds_read_b128 v[136:139], v156
    ds_read_b128 v[140:143], v157
    ds_read_b128 v[144:147], v158
    ds_read_b128 v[148:151], v159
    ds_read_b128 v[152:155], v160
    buffer_store_dwordx4 v[128:131], v15, s[32:35], 0 offen sc1
    buffer_store_dwordx4 v[132:135], v15, s[32:35], s50 offen sc1
    s_mov_b32 s54, 0
    s_waitcnt lgkmcnt(4)
    buffer_store_dwordx4 v[136:139], v15, s[36:39], s54 offen sc1
    s_mov_b32 s54, 8192
    s_waitcnt lgkmcnt(3)
    buffer_store_dwordx4 v[140:143], v15, s[36:39], s54 offen sc1
    s_mov_b32 s54, 16384
    s_waitcnt lgkmcnt(2)
    buffer_store_dwordx4 v[144:147], v15, s[36:39], s54 offen sc1
    s_mov_b32 s54, 24576
    s_waitcnt lgkmcnt(1)
    buffer_store_dwordx4 v[148:151], v15, s[36:39], s54 offen sc1
    s_mov_b32 s54, 32768
    s_waitcnt lgkmcnt(0)
    buffer_store_dwordx4 v[152:155], v15, s[36:39], s54 offen sc1
    s_and_b32 s44, s2, 7
    s_lshl_b32 s44, s44, 5
    s_lshr_b32 s54, s2, 3
    s_add_u32 s44, s44, s54
    s_mul_i32 s45, s44, 625
    s_add_u32 s46, s45, 640
    s_add_u32 s45, s45, 15
    s_lshr_b32 s45, s45, 4
    s_lshr_b32 s46, s46, 4
    s_sub_u32 s46, s46, s45
    v_bfe_i32 v168, v1, 2, 1
    v_and_b32 v168, 0xaaaa, v168
    v_add_u32 v168, 0x4444, v168
    v_mov_b32 v169, 158720
    v_and_b32 v11, 60, v9
    v_add_u32 v11, v11, v169
    ds_write_b32 v11, v13
    v_and_b32 v11, 4, v1
    v_lshlrev_b32 v11, 2, v11
    v_mov_b32 v12, 0xffff
    v_lshlrev_b32 v12, v11, v12
    v_bfe_i32 v11, v1, 3, 1
    v_and_b32 v191, v11, v12
    v_xor_b32 v190, v191, v12
    v_mov_b32 v11, 0x0c0c0c0c
    v_mov_b32 v12, 0x03020302
    v_bfi_b32 v254, v190, v12, v11
    v_bfi_b32 v255, v191, v12, v11
    v_mov_b32 v12, 0x01000100
    v_bfi_b32 v190, v190, v12, v11
    v_bfi_b32 v191, v191, v12, v11
    v_lshrrev_b32 v200, 5, v1
    v_lshlrev_b32 v200, 4, v200
    v_add_u32 v200, 101376, v200
    v_and_b32 v201, 15, v1
    v_lshlrev_b32 v201, 2, v201
    v_bfe_u32 v11, v1, 3, 2
    v_and_b32 v12, 3, v1
    v_lshl_add_u32 v11, v11, 2, v12
    v_lshlrev_b32 v202, 2, v11
    v_bfe_i32 v240, v0, 0, 1
    s_lshl_b32 s54, s3, 10
    v_and_b32 v241, 4, v240
    v_add_u32 v241, s54, v241
    v_lshl_add_u32 v242, v1, 2, s54
    v_lshrrev_b32 v243, 1, v1
    v_lshl_add_u32 v243, v243, 2, s54
    v_mul_u32_u24 v244, 12, v1
    v_and_b32 v245, 12, v242
    v_and_b32 v250, 124, v242
    s_mul_i32 s54, s3, 224
    v_add_u32 v247, s54, v1
    v_lshlrev_b32 v246, 3, v247
    v_add_u32 v246, 87040, v246
    v_lshlrev_b32 v247, 21, v247
    s_mul_i32 s54, s3, 640
    v_add_u32 v248, s54, v250
    v_sub_u32 v249, 63, v1
    s_getreg_b32 s86, hwreg(HW_REG_XCC_ID, 0, 3)
    s_lshl_b32 s54, s86, 4
    v_subrev_u32 v250, s54, v250
    v_and_b32 v250, 124, v250
    v_min_u32 v251, 39, v1
    v_lshlrev_b32 v251, 7, v251
    v_mov_b32 v253, 0x380
    v_lshrrev_b32 v252, 3, v1
    v_mul_u32_u24 v252, 64, v252
    v_add_u32 v252, 78848, v252
    s_lshr_b32 s87, s3, 1
    s_mul_i32 s87, s87, 3
    s_min_u32 s87, s87, 8
    s_mul_i32 s54, s87, 4608
    v_and_b32 v11, 15, v1
    v_lshrrev_b32 v12, 4, v1
    v_mul_u32_u24 v213, 288, v11
    v_lshl_add_u32 v213, v12, 4, v213
    v_add_u32 v213, s54, v213
    v_lshrrev_b32 v12, 3, v1
    v_lshlrev_b32 v12, 9, v12
    v_and_b32 v11, 7, v1
    v_lshl_add_u32 v214, v11, 4, v12
    s_lshl_b32 s87, s87, 12
    s_and_b32 s54, s3, 1
    s_lshl_b32 s54, s54, 7
    s_add_u32 s87, s87, s54
    s_lshl_b32 s54, s54, 7
    s_add_u32 s54, s54, 46080
    v_add_u32 v215, s54, v2
    s_cmp_eq_u32 s46, 40
    v_mov_b32 v203, 0
    s_mov_b32 s54, 685900808
    s_cselect_b32 s54, 568459824, s54
    s_mov_b32 exec_lo, 31
    s_mov_b32 exec_hi, 0
    v_mov_b32 v203, s54
    s_mov_b32 s54, 182814793
    s_cselect_b32 s54, 23232528, s54
    s_mov_b32 exec_lo, 992
    s_mov_b32 exec_hi, 0
    v_mov_b32 v203, s54
    s_mov_b32 s54, 984091248
    s_cselect_b32 s54, 719688297, s54
    s_mov_b32 exec_lo, 31744
    s_mov_b32 exec_hi, 0
    v_mov_b32 v203, s54
    s_mov_b32 s54, 424091761
    s_cselect_b32 s54, 984423522, s54
    s_mov_b32 exec_lo, 1015808
    s_mov_b32 exec_hi, 0
    v_mov_b32 v203, s54
    s_mov_b32 s54, 586001611
    s_cselect_b32 s54, 172635826, s54
    s_mov_b32 exec_lo, 32505856
    s_mov_b32 exec_hi, 0
    v_mov_b32 v203, s54
    s_mov_b32 s54, 64039106
    s_cselect_b32 s54, 454017211, s54
    s_mov_b32 exec_lo, 1040187392
    s_mov_b32 exec_hi, 0
    v_mov_b32 v203, s54
    s_mov_b32 s54, 330320603
    s_cselect_b32 s54, 743654643, s54
    s_mov_b32 exec_lo, 3221225472
    s_mov_b32 exec_hi, 7
    v_mov_b32 v203, s54
    s_mov_b32 s54, 217139484
    s_cselect_b32 s54, 607143691, s54
    s_mov_b32 exec_lo, 0
    s_mov_b32 exec_hi, 248
    v_mov_b32 v203, s54
    s_mov_b64 exec, -1
    v_mul_u32_u24 v11, 52, v1
    v_lshrrev_b32 v11, 8, v11
    v_mad_i32_i24 v11, v11, -5, v1
    v_mul_u32_u24 v11, 6, v11
    v_lshrrev_b32 v203, v11, v203
    v_and_b32 v11, 7, v203
    v_bfe_u32 v203, v203, 3, 3
    v_lshlrev_b32 v11, 12, v11
    v_lshl_or_b32 v203, v203, 7, v11
    s_add_u32 s24, s14, 1048576
    s_addc_u32 s25, s15, 0
    s_mov_b32 s26, 3932160
    s_mov_b32 s27, 0x20000
    v_mov_b32 v16, 0
    v_mov_b32 v17, 0
    v_mov_b32 v18, 0
    v_mov_b32 v19, 0
    v_mov_b32 v20, 0
    v_mov_b32 v21, 0
    v_mov_b32 v22, 0
    v_mov_b32 v23, 0
    v_mov_b32 v24, 0
    v_mov_b32 v25, 0
    v_mov_b32 v26, 0
    v_mov_b32 v27, 0
    v_mov_b32 v28, 0
    v_mov_b32 v29, 0
    v_mov_b32 v30, 0
    v_mov_b32 v31, 0
    v_mov_b32 v32, 0
    v_mov_b32 v33, 0
    v_mov_b32 v34, 0
    v_mov_b32 v35, 0
    v_mov_b32 v36, 0
    v_mov_b32 v37, 0
    v_mov_b32 v38, 0
    v_mov_b32 v39, 0
    v_mov_b32 v40, 0
    v_mov_b32 v41, 0
    v_mov_b32 v42, 0
    v_mov_b32 v43, 0
    v_mov_b32 v44, 0
    v_mov_b32 v45, 0
    v_mov_b32 v46, 0
    v_mov_b32 v47, 0
    v_mov_b32 v48, 0
    v_mov_b32 v49, 0
    v_mov_b32 v50, 0
    v_mov_b32 v51, 0
    v_mov_b32 v52, 0
    v_mov_b32 v53, 0
    v_mov_b32 v54, 0
    v_mov_b32 v55, 0
    v_mov_b32 v56, 0
    v_mov_b32 v57, 0
    v_mov_b32 v58, 0
    v_mov_b32 v59, 0
    v_mov_b32 v60, 0
    v_mov_b32 v61, 0
    v_mov_b32 v62, 0
    v_mov_b32 v63, 0
    s_lshl_b32 s54, s2, 3
    s_add_u32 s54, s54, s3
    s_lshl_b32 s54, s54, 8
    s_mov_b32 s16, s64
    s_mov_b32 s17, s65
    s_mov_b32 s18, 10240000
    s_mov_b32 s19, 0x20000
    s_add_u32 s28, s14, 5767168
    s_addc_u32 s29, s15, 0
    s_mov_b32 s30, 10485760
    s_mov_b32 s31, 0x20000
    s_and_b32 s51, s86, 7
    s_mul_i32 s51, s51, 1282048
    s_and_b32 s55, s2, 0xf8
    s_add_u32 s55, s55, s3
    s_mul_i32 s55, s55, 2304
    s_add_u32 s51, s51, s55
    v_min_u32 v7, 17, v1
    v_lshlrev_b32 v7, 7, v7
    s_waitcnt vmcnt(0)
    s_barrier
    s_mov_b64 exec, 0xffff
    buffer_store_dwordx4 v[112:115], v2, s[20:23], s54 offen sc1
    s_mov_b64 exec, -1
    buffer_load_dword v7, v7, s[16:19], s51 offen
    s_lshl_b32 s54, s45, 10
    s_add_u32 s40, s12, s54
    s_addc_u32 s41, s13, 0
    s_lshl_b32 s42, s46, 10
    s_mov_b32 s43, 0x20000
    v_lshrrev_b32 v8, 5, v1
    v_lshlrev_b32 v8, 10, v8
    v_and_b32 v9, 15, v1
    v_lshl_add_u32 v8, v9, 4, v8
    ds_read_b128 v[64:67], v8 offset:17408
    ds_read_b128 v[68:71], v8 offset:17664
    ds_read_b128 v[72:75], v8 offset:17920
    ds_read_b128 v[76:79], v8 offset:18176
    ds_read_b128 v[80:83], v8 offset:19456
    ds_read_b128 v[84:87], v8 offset:19712
    ds_read_b128 v[88:91], v8 offset:19968
    ds_read_b128 v[92:95], v8 offset:20224
    v_lshrrev_b32 v8, 4, v1
    v_lshlrev_b32 v8, 5, v8
    v_and_b32 v9, 3, v1
    v_lshl_add_u32 v8, v9, 1, v8
    ds_read_u16 v96, v8 offset:21504
    ds_read_u16 v97, v8 offset:21512
    ds_read_u16 v98, v8 offset:21520
    ds_read_u16 v99, v8 offset:21528
    v_bfe_i32 v10, v1, 4, 1
    v_and_b32 v10, 0x02020202, v10
    v_add_u32 v10, 0x05040100, v10
    s_waitcnt lgkmcnt(0)
    v_perm_b32 v172, v68, v64, v10
    v_perm_b32 v174, v76, v72, v10
    v_perm_b32 v176, v84, v80, v10
    v_perm_b32 v178, v92, v88, v10
    v_perm_b32 v173, v69, v65, v10
    v_perm_b32 v175, v77, v73, v10
    v_perm_b32 v177, v85, v81, v10
    v_perm_b32 v179, v93, v89, v10
    v_perm_b32 v180, v70, v66, v10
    v_perm_b32 v182, v78, v74, v10
    v_perm_b32 v184, v86, v82, v10
    v_perm_b32 v186, v94, v90, v10
    v_perm_b32 v181, v71, v67, v10
    v_perm_b32 v183, v79, v75, v10
    v_perm_b32 v185, v87, v83, v10
    v_perm_b32 v187, v95, v91, v10
    v_lshl_or_b32 v188, v97, 16, v96
    v_lshl_or_b32 v189, v99, 16, v98
    v_and_b32 v9, 7, v1
    v_lshrrev_b32 v8, 4, v1
    v_lshlrev_b32 v8, 13, v8
    v_lshl_add_u32 v8, v9, 4, v8
    v_and_b32 v9, 8, v1
    s_and_b32 s72, s3, 3
    s_lshl_b32 s72, s72, 8
    s_lshr_b32 s73, s3, 2
    s_lshl_b32 s73, s73, 7
    s_add_u32 s72, s72, s73
    s_add_u32 s72, s72, 46080
    v_add3_u32 v8, v8, v9, s72
    ds_read2st64_b64 v[128:131], v8 offset0:0 offset1:2
    ds_read2st64_b64 v[132:135], v8 offset0:4 offset1:6
    ds_read2st64_b64 v[136:139], v8 offset0:8 offset1:10
    ds_read2st64_b64 v[140:143], v8 offset0:12 offset1:14
    s_mov_b32 s72, 0x05040100
    s_mov_b32 s73, 0x07060302
    s_waitcnt lgkmcnt(3)
    v_perm_b32 v144, v130, v128, s72
    v_perm_b32 v148, v130, v128, s73
    v_perm_b32 v152, v131, v129, s72
    v_perm_b32 v156, v131, v129, s73
    s_waitcnt lgkmcnt(2)
    v_perm_b32 v145, v134, v132, s72
    v_perm_b32 v149, v134, v132, s73
    v_perm_b32 v153, v135, v133, s72
    v_perm_b32 v157, v135, v133, s73
    s_waitcnt lgkmcnt(1)
    v_perm_b32 v146, v138, v136, s72
    v_perm_b32 v150, v138, v136, s73
    v_perm_b32 v154, v139, v137, s72
    v_perm_b32 v158, v139, v137, s73
    s_waitcnt lgkmcnt(0)
    v_perm_b32 v147, v142, v140, s72
    v_perm_b32 v151, v142, v140, s73
    v_perm_b32 v155, v143, v141, s72
    v_perm_b32 v159, v143, v141, s73
    v_mov_b32 v64, 0
    v_mov_b32 v65, 0
    v_mov_b32 v66, 0
    v_mov_b32 v67, 0
    v_mov_b32 v68, 0
    v_mov_b32 v69, 0
    v_mov_b32 v70, 0
    v_mov_b32 v71, 0
    v_mov_b32 v72, 0
    v_mov_b32 v73, 0
    v_mov_b32 v74, 0
    v_mov_b32 v75, 0
    v_mov_b32 v76, 0
    v_mov_b32 v77, 0
    v_mov_b32 v78, 0
    v_mov_b32 v79, 0
    v_mov_b32 v80, 0
    v_mov_b32 v81, 0
    v_mov_b32 v82, 0
    v_mov_b32 v83, 0
    v_mov_b32 v84, 0
    v_mov_b32 v85, 0
    v_mov_b32 v86, 0
    v_mov_b32 v87, 0
    v_mov_b32 v88, 0
    v_mov_b32 v89, 0
    v_mov_b32 v90, 0
    v_mov_b32 v91, 0
    v_mov_b32 v92, 0
    v_mov_b32 v93, 0
    v_mov_b32 v94, 0
    v_mov_b32 v95, 0
    s_lshl_b32 s54, s3, 12
    v_add_u32 v8, s54, v2
    v_lshrrev_b32 v9, 1, v0
    v_lshlrev_b32 v10, 11, v9
    s_lshl_b32 s49, s44, 3
    v_mul_u32_u24 v5, 1280, v9
    s_mov_b32 s48, 0
    s_mov_b32 s53, 200000
    s_mov_b32 s55, 0xffc00000
    s_mul_i32 s52, s3, 7168
    s_add_u32 s52, s52, 101376
    s_movk_i32 s98, 4096
    s_waitcnt vmcnt(0)
    s_barrier
    buffer_load_dwordx2 v[206:207], v10, s[20:23], s49 offen sc1
    ds_write_b128 v8, v[144:147] offset:46080
    ds_write_b128 v8, v[148:151] offset:47104
    ds_write_b128 v8, v[152:155] offset:48128
    ds_write_b128 v8, v[156:159] offset:49152
    s_waitcnt vmcnt(0)
    v_xor_b32 v11, s63, v206
    v_xor_b32 v12, s62, v207
    v_and_or_b32 v11, v11, s55, v12
    v_cmpx_ne_u32 vcc, 0, v11
    s_cbranch_execnz L_poll
L_polled:
    s_mov_b64 exec, -1
    v_bfe_u32 v3, v206, 11, 11
    v_and_b32 v4, v3, v240
    v_add_u32 v10, v3, v240
    v_and_b32 v11, 0x7ff, v206
    v_add_u32_dpp v4, v4, v4 row_shr:1 row_mask:0xf bank_mask:0xf
    v_cmp_lt_i32 s[64:65], 0, v10
    v_cmp_lt_i32 s[66:67], 2, v10
    v_add_u32_dpp v4, v4, v4 row_shr:2 row_mask:0xf bank_mask:0xf
    v_cmp_lt_i32 s[68:69], 4, v10
    v_cmp_lt_i32 s[70:71], 6, v10
    v_add_u32_dpp v4, v4, v4 row_shr:4 row_mask:0xf bank_mask:0xf
    v_cmp_lt_i32 s[72:73], 8, v10
    v_cmp_lt_i32 s[74:75], 10, v10
    v_add_u32_dpp v4, v4, v4 row_shr:8 row_mask:0xf bank_mask:0xf
    v_cmp_lt_i32 s[76:77], 12, v10
    v_cmp_lt_i32 s[78:79], 14, v10
    v_add_u32_dpp v4, v4, v4 row_bcast:15 row_mask:0xa bank_mask:0xf
    v_add_u32 v5, v5, v11
    s_nop 0
    v_add_u32_dpp v4, v4, v4 row_bcast:31 row_mask:0xc bank_mask:0xf
    s_nop 0
    v_readlane_b32 s95, v4, 63
    v_mov_b32_dpp v4, v4 quad_perm:[0,0,2,2] row_mask:0xf bank_mask:0xf
    v_sub_u32 v5, v5, v4
    v_lshl_add_u32 v8, v4, 2, v241
    s_cmp_gt_u32 s95, 224
    s_cbranch_scc1 L_clip
L_mapw:
    s_mov_b64 exec, s[64:65]
    ds_write_b32 v8, v5 offset:0
    s_mov_b64 exec, s[66:67]
    ds_write_b32 v8, v5 offset:8
    s_mov_b64 exec, s[68:69]
    ds_write_b32 v8, v5 offset:16
    s_mov_b64 exec, s[70:71]
    ds_write_b32 v8, v5 offset:24
    s_mov_b64 exec, s[72:73]
    ds_write_b32 v8, v5 offset:32
    s_mov_b64 exec, s[74:75]
    ds_write_b32 v8, v5 offset:40
    s_mov_b64 exec, s[76:77]
    ds_write_b32 v8, v5 offset:48
    s_mov_b64 exec, -1
    s_cmp_lg_u64 s[78:79], 0
    s_cbranch_scc1 L_map2
    ds_read_b32 v136, v242 offset:0
    ds_read_b32 v137, v242 offset:256
    ds_read_b32 v138, v242 offset:512
    ds_read_b32 v140, v243 offset:0
    ds_read_b32 v141, v243 offset:128
    ds_read_b32 v142, v243 offset:256
    ds_read_b32 v143, v243 offset:384
    ds_read_b32 v144, v243 offset:512
    ds_read_b32 v145, v243 offset:640
    s_cmp_gt_i32 s95, 192
    s_cbranch_scc1 L_r1
L_r1b:
    s_waitcnt lgkmcnt(6)
    v_mad_u32_u24 v136, v136, 12, v244
    buffer_load_dwordx3 v[148:150], v136, s[24:27], 0 offen offset:0 sc1
    v_mad_u32_u24 v137, v137, 12, v244
    buffer_load_dwordx3 v[152:154], v137, s[24:27], 0 offen offset:768 sc1
    v_mad_u32_u24 v138, v138, 12, v244
    buffer_load_dwordx3 v[156:158], v138, s[24:27], 0 offen offset:1536 sc1
    v_mov_b32 v11, s95
    s_mov_b64 exec, 1
    ds_max_i32 v13, v11 offset:15360
    s_mov_b64 exec, -1
    s_waitcnt lgkmcnt(1)
    v_lshl_add_u32 v140, v140, 5, v2
    v_lshl_add_u32 v141, v141, 5, v2
    v_lshl_add_u32 v142, v142, 5, v2
    v_lshl_add_u32 v143, v143, 5, v2
    v_lshl_add_u32 v144, v144, 5, v2
    v_lshl_add_u32 v145, v145, 5, v2
    s_barrier
    s_add_u32 m0, s52, 0
    s_nop 0
    buffer_load_dwordx4 v140, s[28:31], 0 offen offset:0 sc1 lds
    buffer_load_dwordx4 v141, s[28:31], 0 offen offset:1024 sc1 lds
    s_min_i32 s54, s95, 224
    v_cmp_gt_i32 s[80:81], s54, v1
    s_sub_i32 s54, s54, 64
    v_cmp_gt_i32 s[82:83], s54, v1
    s_sub_i32 s54, s54, 64
    v_cmp_gt_i32 s[84:85], s54, v1
    s_sub_i32 s54, s54, 64
    v_cmp_gt_i32 s[96:97], s54, v1
    s_sub_i32 s54, s54, 64
    s_mov_b32 s55, 0x1fff80
    s_mul_i32 s61, s3, 5
    ds_read_b128 v[216:219], v215 offset:0
    ds_read_b128 v[220:223], v215 offset:1024
    ds_read_b128 v[224:227], v215 offset:2048
    ds_read_b128 v[228:231], v215 offset:3072
    ds_read_b128 v[232:235], v215 offset:4096
    ds_read_b128 v[236:239], v215 offset:5120
    s_waitcnt vmcnt(4)
    v_lshrrev_b32 v132, 21, v150
    v_lshlrev_b32 v132, 2, v132
    v_lshrrev_b32 v11, 26, v150
    v_lshl_or_b32 v11, v11, 4, v245
    s_mov_b64 exec, s[80:81]
    ds_add_rtn_u32 v128, v132, v6 offset:8192
    ds_add_u32 v11, v6 offset:14336
    s_mov_b64 exec, -1
    s_waitcnt vmcnt(3)
    v_lshrrev_b32 v133, 21, v154
    v_lshlrev_b32 v133, 2, v133
    v_lshrrev_b32 v11, 26, v154
    v_lshl_or_b32 v11, v11, 4, v245
    s_mov_b64 exec, s[82:83]
    ds_add_rtn_u32 v129, v133, v6 offset:8192
    ds_add_u32 v11, v6 offset:14336
    s_mov_b64 exec, -1
    s_waitcnt vmcnt(2)
    v_lshrrev_b32 v134, 21, v158
    v_lshlrev_b32 v134, 2, v134
    v_lshrrev_b32 v11, 26, v158
    v_lshl_or_b32 v11, v11, 4, v245
    s_mov_b64 exec, s[84:85]
    ds_add_rtn_u32 v130, v134, v6 offset:8192
    ds_add_u32 v11, v6 offset:14336
    s_mov_b64 exec, -1
    s_cmp_gt_i32 s95, 192
    s_cbranch_scc1 L_r2
L_r2b:
    s_or_b32 s54, s2, s3
    s_cbranch_scc0 L_tag
L_tagged:
    buffer_load_dwordx4 v142, s[28:31], 0 offen offset:2048 sc1 lds
    s_add_u32 s65, s61, 1
    s_add_u32 s66, s61, 2
    s_add_u32 s67, s61, 3
    s_add_u32 s68, s61, 4
    s_waitcnt lgkmcnt(0)
    s_barrier
    s_cmp_lg_u32 s48, 0
    s_cbranch_scc1 L_rank2
    ds_read_b128 v[104:107], v2 offset:14336
    ds_read_b32 v96, v248 offset:8192
    ds_read_b32 v97, v248 offset:8320
    ds_read_b32 v98, v248 offset:8448
    ds_read_b32 v99, v248 offset:8576
    ds_read_b32 v100, v248 offset:8704
    ds_read_b32 v14, v13 offset:15360
    ds_write_b64 v246, v[148:149] offset:0
    v_and_or_b32 v150, v150, s55, v247
    ds_write_b64 v246, v[152:153] offset:512
    v_and_or_b32 v154, v154, s55, v247
    v_add_u32 v154, 134217728, v154
    ds_write_b64 v246, v[156:157] offset:1024
    v_and_or_b32 v158, v158, s55, v247
    v_add_u32 v158, 268435456, v158
    s_waitcnt lgkmcnt(9)
    v_add_u32 v9, v104, v105
    v_add3_u32 v9, v9, v106, v107
    v_lshl_or_b32 v9, v9, 6, v249
    s_nop 0
    v_readlane_b32 s64, v9, s61
    v_readlane_b32 s65, v9, s65
    v_readlane_b32 s66, v9, s66
    v_readlane_b32 s67, v9, s67
    v_readlane_b32 s68, v9, s68
    v_cmp_lt_u32 s[70:71], s64, v9
    v_cmp_lt_u32 s[72:73], s65, v9
    v_cmp_lt_u32 s[74:75], s66, v9
    v_cmp_lt_u32 s[76:77], s67, v9
    v_cmp_lt_u32 s[78:79], s68, v9
    s_bcnt1_i32_b64 s64, s[70:71]
    s_bcnt1_i32_b64 s65, s[72:73]
    s_bcnt1_i32_b64 s66, s[74:75]
    s_bcnt1_i32_b64 s67, s[76:77]
    s_bcnt1_i32_b64 s68, s[78:79]
    s_waitcnt lgkmcnt(3)
    v_readlane_b32 s90, v203, s64
    v_readlane_b32 s91, v203, s65
    v_readlane_b32 s92, v203, s66
    v_readlane_b32 s93, v203, s67
    v_readlane_b32 s94, v203, s68
    v_readfirstlane_b32 s47, v14
L_ranked:
    s_mov_b32 exec_hi, 0
    v_and_or_b32 v104, s90, v253, v250
    ds_add_rtn_u32 v96, v104, v96 offset:13312
    v_and_or_b32 v105, s91, v253, v250
    ds_add_rtn_u32 v97, v105, v97 offset:13312
    v_and_or_b32 v106, s92, v253, v250
    ds_add_rtn_u32 v98, v106, v98 offset:13312
    v_and_or_b32 v107, s93, v253, v250
    ds_add_rtn_u32 v99, v107, v99 offset:13312
    v_and_or_b32 v108, s94, v253, v250
    ds_add_rtn_u32 v100, v108, v100 offset:13312
    v_or_b32 v104, s90, v250
    v_or_b32 v105, s91, v250
    v_or_b32 v106, s92, v250
    v_or_b32 v107, s93, v250
    v_or_b32 v108, s94, v250
    s_lshl_b32 s54, s3, 3
    s_add_u32 s61, s54, 7
    s_waitcnt lgkmcnt(3)
    v_lshl_or_b32 v96, v96, 16, v104
    ds_write_b32 v248, v96 offset:8192
    v_lshl_or_b32 v97, v97, 16, v105
    ds_write_b32 v248, v97 offset:8320
    s_waitcnt lgkmcnt(2)
    v_lshl_or_b32 v98, v98, 16, v106
    ds_write_b32 v248, v98 offset:8448
    v_lshl_or_b32 v99, v99, 16, v107
    ds_write_b32 v248, v99 offset:8576
    v_lshl_or_b32 v100, v100, 16, v108
    ds_write_b32 v248, v100 offset:8704
    s_mov_b32 exec_hi, -1
    buffer_load_dwordx4 v143, s[28:31], 0 offen offset:3072 sc1 lds
    s_add_u32 m0, s52, 4096
    s_nop 0
    buffer_load_dwordx4 v144, s[28:31], s98 offen offset:0 sc1 lds
    s_waitcnt lgkmcnt(0)
    s_barrier
    ds_read_b128 v[96:99], v2 offset:13312
    ds_read_b32 v132, v132 offset:8192
    ds_read_b32 v133, v133 offset:8192
    ds_read_b32 v134, v134 offset:8192
    s_waitcnt lgkmcnt(3)
    v_add_u32 v9, v96, v97
    v_add3_u32 v9, v9, v98, v99
    v_mov_b32 v10, v9
    s_waitcnt lgkmcnt(0)
    v_bfe_u32 v15, v132, 12, 3
    v_add_u32_dpp v10, v10, v10 row_shr:1 row_mask:0xf bank_mask:0xf
    v_or_b32 v150, v15, v150
    v_and_b32 v136, 0x3ff, v132
    v_add_u32_dpp v10, v10, v10 row_shr:2 row_mask:0xf bank_mask:0xf
    v_lshrrev_b32 v132, 16, v132
    v_add_u32 v132, v132, v128
    v_add_u32_dpp v10, v10, v10 row_shr:4 row_mask:0xf bank_mask:0xf
    v_bfe_u32 v15, v133, 12, 3
    v_or_b32 v154, v15, v154
    v_add_u32_dpp v10, v10, v10 row_shr:8 row_mask:0xf bank_mask:0xf
    v_and_b32 v137, 0x3ff, v133
    v_lshrrev_b32 v133, 16, v133
    v_add_u32_dpp v10, v10, v10 row_bcast:15 row_mask:0xa bank_mask:0xf
    v_add_u32 v133, v133, v129
    v_bfe_u32 v15, v134, 12, 3
    v_add_u32_dpp v10, v10, v10 row_bcast:31 row_mask:0xc bank_mask:0xf
    v_or_b32 v158, v15, v158
    v_and_b32 v138, 0x3ff, v134
    v_sub_u32 v9, v10, v9
    v_lshl_add_u32 v104, v9, 2, v252
    v_lshl_add_u32 v105, v96, 2, v104
    v_lshl_add_u32 v106, v97, 2, v105
    v_lshl_add_u32 v107, v98, 2, v106
    ds_write_b128 v2, v[104:107] offset:16384
    ds_read_b32 v136, v136 offset:16384
    ds_read_b32 v137, v137 offset:16384
    ds_read_b32 v138, v138 offset:16384
    v_lshrrev_b32 v134, 16, v134
    v_add_u32 v134, v134, v130
    v_readlane_b32 s50, v10, s61
    v_readlane_b32 s53, v9, s54
    v_readlane_b32 s51, v104, s54
    v_mov_b32 v14, 2097029
    s_sub_u32 s50, s50, s53
    s_lshl2_add_u32 s55, s50, s51
    v_add_u32 v9, s55, v201
    ds_write_b32 v9, v14
    s_add_u32 s53, s50, 15
    s_lshr_b32 s53, s53, 4
    s_sub_u32 s54, 0, s50
    s_and_b32 s54, s54, 14
    s_sub_u32 s53, s53, 1
    s_cmp_gt_i32 s53, 0
    s_cselect_b32 s54, s54, 0
    s_lshl_b32 s61, s54, 2
    s_sub_u32 s51, s51, s61
    s_waitcnt lgkmcnt(1)
    v_lshl_add_u32 v132, v132, 2, v136
    v_lshl_add_u32 v133, v133, 2, v137
    v_lshl_add_u32 v134, v134, 2, v138
    s_mov_b64 exec, s[80:81]
    ds_write_b32 v132, v150
    s_mov_b64 exec, s[82:83]
    ds_write_b32 v133, v154
    s_mov_b64 exec, s[84:85]
    ds_write_b32 v134, v158
    s_mov_b64 exec, -1
    s_cmp_gt_i32 s95, 192
    s_cbranch_scc1 L_r3
L_r3b:
    buffer_load_dwordx4 v145, s[28:31], s98 offen offset:1024 sc1 lds
    v_add_u32 v198, s51, v201
    v_add_u32 v199, s51, v202
    s_and_b32 s61, s61, 32
    v_add_u32 v12, s61, v198
    s_and_b32 s72, s54, 6
    s_mov_b32 s55, 0x00fffc38
    s_mov_b32 s49, 0xffffff00
    s_mov_b32 s51, 87040
    s_cmp_lt_u32 s3, 4
    s_cbranch_scc1 L_np
    s_setprio 1
L_np:
    s_waitcnt lgkmcnt(0)
    s_barrier
    ds_read_b32 v196, v12
    ds_read_b32 v194, v199
    ds_read_b32 v197, v198 offset:24
    ds_read_b32 v205, v251 offset:8192
    s_cmp_eq_u32 s50, 0
    s_cbranch_scc1 L_empty
    s_waitcnt lgkmcnt(3)
    v_lshlrev_b32 v196, 3, v196
    v_and_b32 v196, s55, v196
    s_cmp_eq_u32 s72, 2
    s_cbranch_scc1 L_p2
    s_cmp_eq_u32 s72, 4
    s_cbranch_scc1 L_p4
    s_cmp_eq_u32 s72, 6
    s_cbranch_scc1 L_p6
L_p0:
    v_readlane_b32 s64, v196, 0
    v_readlane_b32 s65, v196, 1
    s_and_b32 s61, s64, s49
    buffer_load_dwordx4 v[96:99], v2, s[16:19], s61 offen
    s_and_b32 s61, s65, s49
    buffer_load_dwordx4 v[100:103], v2, s[16:19], s61 offen
    s_waitcnt vmcnt(2) lgkmcnt(0)
    s_barrier
    v_lshrrev_b32 v8, 21, v194
    v_lshl_add_u32 v11, v8, 3, s51
    v_lshl_add_u32 v8, v8, 5, v200
    ds_read_b64 v[192:193], v11
    ds_read_b128 v[164:167], v8
    v_readlane_b32 s66, v196, 2
    v_readlane_b32 s67, v196, 3
    s_and_b32 s61, s66, s49
    buffer_load_dwordx4 v[104:107], v2, s[16:19], s61 offen
    s_and_b32 s61, s67, s49
    buffer_load_dwordx4 v[108:111], v2, s[16:19], s61 offen
    v_readlane_b32 s68, v196, 4
    v_readlane_b32 s69, v196, 5
    s_and_b32 s61, s68, s49
    buffer_load_dwordx4 v[112:115], v2, s[16:19], s61 offen
    s_and_b32 s61, s69, s49
    buffer_load_dwordx4 v[116:119], v2, s[16:19], s61 offen
    s_branch L_pd
L_p2:
    v_readlane_b32 s66, v196, 2
    v_readlane_b32 s67, v196, 3
    s_and_b32 s61, s66, s49
    buffer_load_dwordx4 v[104:107], v2, s[16:19], s61 offen
    s_and_b32 s61, s67, s49
    buffer_load_dwordx4 v[108:111], v2, s[16:19], s61 offen
    s_waitcnt vmcnt(2) lgkmcnt(0)
    s_barrier
    v_lshrrev_b32 v8, 21, v194
    v_lshl_add_u32 v11, v8, 3, s51
    v_lshl_add_u32 v8, v8, 5, v200
    ds_read_b64 v[192:193], v11
    ds_read_b128 v[164:167], v8
    v_readlane_b32 s68, v196, 4
    v_readlane_b32 s69, v196, 5
    s_and_b32 s61, s68, s49
    buffer_load_dwordx4 v[112:115], v2, s[16:19], s61 offen
    s_and_b32 s61, s69, s49
    buffer_load_dwordx4 v[116:119], v2, s[16:19], s61 offen
    v_readlane_b32 s70, v196, 6
    v_readlane_b32 s71, v196, 7
    s_and_b32 s61, s70, s49
    buffer_load_dwordx4 v[120:123], v2, s[16:19], s61 offen
    s_and_b32 s61, s71, s49
    buffer_load_dwordx4 v[124:127], v2, s[16:19], s61 offen
    s_branch L_pd
L_p4:
    v_readlane_b32 s68, v196, 4
    v_readlane_b32 s69, v196, 5
    s_and_b32 s61, s68, s49
    buffer_load_dwordx4 v[112:115], v2, s[16:19], s61 offen
    s_and_b32 s61, s69, s49
    buffer_load_dwordx4 v[116:119], v2, s[16:19], s61 offen
    s_waitcnt vmcnt(2) lgkmcnt(0)
    s_barrier
    v_lshrrev_b32 v8, 21, v194
    v_lshl_add_u32 v11, v8, 3, s51
    v_lshl_add_u32 v8, v8, 5, v200
    ds_read_b64 v[192:193], v11
    ds_read_b128 v[164:167], v8
    v_readlane_b32 s70, v196, 6
    v_readlane_b32 s71, v196, 7
    s_and_b32 s61, s70, s49
    buffer_load_dwordx4 v[120:123], v2, s[16:19], s61 offen
    s_and_b32 s61, s71, s49
    buffer_load_dwordx4 v[124:127], v2, s[16:19], s61 offen
    v_readlane_b32 s64, v196, 8
    v_readlane_b32 s65, v196, 9
    s_and_b32 s61, s64, s49
    buffer_load_dwordx4 v[96:99], v2, s[16:19], s61 offen
    s_and_b32 s61, s65, s49
    buffer_load_dwordx4 v[100:103], v2, s[16:19], s61 offen
    s_branch L_pd
L_p6:
    v_readlane_b32 s70, v196, 6
    v_readlane_b32 s71, v196, 7
    s_and_b32 s61, s70, s49
    buffer_load_dwordx4 v[120:123], v2, s[16:19], s61 offen
    s_and_b32 s61, s71, s49
    buffer_load_dwordx4 v[124:127], v2, s[16:19], s61 offen
    s_waitcnt vmcnt(2) lgkmcnt(0)
    s_barrier
    v_lshrrev_b32 v8, 21, v194
    v_lshl_add_u32 v11, v8, 3, s51
    v_lshl_add_u32 v8, v8, 5, v200
    ds_read_b64 v[192:193], v11
    ds_read_b128 v[164:167], v8
    v_readlane_b32 s64, v196, 8
    v_readlane_b32 s65, v196, 9
    s_and_b32 s61, s64, s49
    buffer_load_dwordx4 v[96:99], v2, s[16:19], s61 offen
    s_and_b32 s61, s65, s49
    buffer_load_dwordx4 v[100:103], v2, s[16:19], s61 offen
    v_readlane_b32 s66, v196, 10
    v_readlane_b32 s67, v196, 11
    s_and_b32 s61, s66, s49
    buffer_load_dwordx4 v[104:107], v2, s[16:19], s61 offen
    s_and_b32 s61, s67, s49
    buffer_load_dwordx4 v[108:111], v2, s[16:19], s61 offen
L_pd:
    s_waitcnt lgkmcnt(0)
    v_mfma_f32_4x4x4_16b_bf16 v[144:147], v[192:193], v[188:189], 0 cbsz:4 abid:0
    v_mfma_f32_4x4x4_16b_bf16 v[148:151], v[192:193], v[188:189], 0 cbsz:4 abid:2
    v_mfma_f32_4x4x4_16b_bf16 v[152:155], v[192:193], v[188:189], 0 cbsz:4 abid:4
    v_mfma_f32_4x4x4_16b_bf16 v[156:159], v[192:193], v[188:189], 0 cbsz:4 abid:6
    v_lshlrev_b32 v196, 3, v197
    v_and_b32 v196, s55, v196
    v_add_u32 v198, 64, v198
    v_add_u32 v199, 64, v199
    v_smfmac_f32_32x32x32_bf16 v[64:79], v[164:167], v[172:179], v168
    ds_read_b32 v197, v198 offset:24
    ds_read_b32 v194, v199
    v_smfmac_f32_32x32x32_bf16 v[80:95], v[164:167], v[180:187], v168
    s_set_gpr_idx_on s54, gpr_idx(SRC0,SRC1)
    v_cvt_pk_bf16_f32 v9, v144, v145
    s_set_gpr_idx_off
    v_perm_b32 v160, v9, v9, v190
    v_perm_b32 v161, v9, v9, v191
    s_waitcnt lgkmcnt(0)
    v_lshrrev_b32 v8, 21, v194
    v_lshl_add_u32 v11, v8, 3, s51
    v_lshl_add_u32 v8, v8, 5, v200
    ds_read_b64 v[192:193], v11
    ds_read_b128 v[164:167], v8
    s_cmp_eq_u32 s53, 0
    s_cbranch_scc1 L_f0
    s_cmp_eq_u32 s54, 0
    s_cbranch_scc1 L_j0
    s_cmp_eq_u32 s54, 2
    s_cbranch_scc1 L_j2
    ds_read_b128 v[64:67], v169
    ds_read_b128 v[80:83], v169
    s_cmp_eq_u32 s54, 4
    s_cbranch_scc1 L_j4
    s_cmp_eq_u32 s54, 6
    s_cbranch_scc1 L_j6
    ds_read_b128 v[68:71], v169
    ds_read_b128 v[84:87], v169
    s_cmp_eq_u32 s54, 8
    s_cbranch_scc1 L_j8
    s_cmp_eq_u32 s54, 10
    s_cbranch_scc1 L_j10
    ds_read_b128 v[72:75], v169
    ds_read_b128 v[88:91], v169
    s_cmp_eq_u32 s54, 12
    s_cbranch_scc1 L_j12
    s_branch L_j14
.p2align 3
L_loop:
    s_waitcnt lgkmcnt(2)
    v_mfma_f32_4x4x4_16b_bf16 v[144:147], v[192:193], v[188:189], 0 cbsz:4 abid:0
    v_mfma_f32_4x4x4_16b_bf16 v[148:151], v[192:193], v[188:189], 0 cbsz:4 abid:2
    v_mfma_f32_4x4x4_16b_bf16 v[152:155], v[192:193], v[188:189], 0 cbsz:4 abid:4
    v_mfma_f32_4x4x4_16b_bf16 v[156:159], v[192:193], v[188:189], 0 cbsz:4 abid:6
    v_lshlrev_b32 v196, 3, v197
    v_and_b32 v196, s55, v196
    v_add_u32 v198, 64, v198
    v_add_u32 v199, 64, v199
    s_waitcnt lgkmcnt(0)
    v_smfmac_f32_32x32x32_bf16 v[64:79], v[164:167], v[172:179], v168
    ds_read_b32 v197, v198 offset:24
    ds_read_b32 v194, v199
    v_cvt_pk_bf16_f32 v9, v144, v145
    v_perm_b32 v160, v9, v9, v190
    v_perm_b32 v161, v9, v9, v191
    v_smfmac_f32_32x32x32_bf16 v[80:95], v[164:167], v[180:187], v168
L_j0:
    s_waitcnt vmcnt(5)
    v_mfma_f32_16x16x16_bf16 v[128:131], v[160:161], v[96:97], 0
    v_readlane_b32 s70, v196, 0
    v_perm_b32 v162, v9, v9, v254
    v_mfma_f32_16x16x16_bf16 v[132:135], v[160:161], v[98:99], 0
    v_perm_b32 v163, v9, v9, v255
    s_and_b32 s61, s70, s49
    s_waitcnt vmcnt(4)
    buffer_load_dwordx4 v[120:123], v2, s[16:19], s61 offen
    v_mfma_f32_16x16x16_bf16 v[136:139], v[162:163], v[100:101], 0
    v_readlane_b32 s71, v196, 1
    v_cvt_pk_bf16_f32 v9, v146, v147
    v_mfma_f32_16x16x16_bf16 v[140:143], v[162:163], v[102:103], 0
    v_perm_b32 v160, v9, v9, v190
    v_perm_b32 v161, v9, v9, v191
    s_and_b32 s61, s71, s49
    s_set_gpr_idx_on s64, gpr_idx(SRC2,DST)
    buffer_load_dwordx4 v[124:127], v2, s[16:19], s61 offen
    v_pk_fma_f32 v[16:17], v[128:129], v[64:65], v[16:17] op_sel_hi:[1,0,1]
    v_pk_fma_f32 v[18:19], v[130:131], v[64:65], v[18:19] op_sel_hi:[1,0,1]
    v_pk_fma_f32 v[20:21], v[132:133], v[80:81], v[20:21] op_sel_hi:[1,0,1]
    v_pk_fma_f32 v[22:23], v[134:135], v[80:81], v[22:23] op_sel_hi:[1,0,1]
    s_set_gpr_idx_idx s65
    v_pk_fma_f32 v[16:17], v[136:137], v[64:65], v[16:17] op_sel:[0,1,0] op_sel_hi:[1,1,1]
    v_pk_fma_f32 v[18:19], v[138:139], v[64:65], v[18:19] op_sel:[0,1,0] op_sel_hi:[1,1,1]
    v_pk_fma_f32 v[20:21], v[140:141], v[80:81], v[20:21] op_sel:[0,1,0] op_sel_hi:[1,1,1]
    v_pk_fma_f32 v[22:23], v[142:143], v[80:81], v[22:23] op_sel:[0,1,0] op_sel_hi:[1,1,1]
    s_set_gpr_idx_off
L_j2:
    s_waitcnt vmcnt(5)
    v_mfma_f32_16x16x16_bf16 v[128:131], v[160:161], v[104:105], 0
    v_readlane_b32 s64, v196, 2
    v_perm_b32 v162, v9, v9, v254
    v_mfma_f32_16x16x16_bf16 v[132:135], v[160:161], v[106:107], 0
    v_perm_b32 v163, v9, v9, v255
    s_and_b32 s61, s64, s49
    s_waitcnt vmcnt(4)
    buffer_load_dwordx4 v[96:99], v2, s[16:19], s61 offen
    v_mfma_f32_16x16x16_bf16 v[136:139], v[162:163], v[108:109], 0
    v_readlane_b32 s65, v196, 3
    v_cvt_pk_bf16_f32 v9, v148, v149
    v_mfma_f32_16x16x16_bf16 v[140:143], v[162:163], v[110:111], 0
    v_perm_b32 v160, v9, v9, v190
    v_perm_b32 v161, v9, v9, v191
    s_waitcnt lgkmcnt(0)
    v_lshrrev_b32 v8, 21, v194
    v_lshl_add_u32 v11, v8, 3, s51
    v_lshl_add_u32 v8, v8, 5, v200
    ds_read_b64 v[192:193], v11
    ds_read_b128 v[164:167], v8
    s_and_b32 s61, s65, s49
    s_set_gpr_idx_on s66, gpr_idx(SRC2,DST)
    buffer_load_dwordx4 v[100:103], v2, s[16:19], s61 offen
    v_pk_fma_f32 v[16:17], v[128:129], v[66:67], v[16:17] op_sel_hi:[1,0,1]
    v_pk_fma_f32 v[18:19], v[130:131], v[66:67], v[18:19] op_sel_hi:[1,0,1]
    v_pk_fma_f32 v[20:21], v[132:133], v[82:83], v[20:21] op_sel_hi:[1,0,1]
    v_pk_fma_f32 v[22:23], v[134:135], v[82:83], v[22:23] op_sel_hi:[1,0,1]
    s_set_gpr_idx_idx s67
    v_pk_fma_f32 v[16:17], v[136:137], v[66:67], v[16:17] op_sel:[0,1,0] op_sel_hi:[1,1,1]
    v_pk_fma_f32 v[18:19], v[138:139], v[66:67], v[18:19] op_sel:[0,1,0] op_sel_hi:[1,1,1]
    v_pk_fma_f32 v[20:21], v[140:141], v[82:83], v[20:21] op_sel:[0,1,0] op_sel_hi:[1,1,1]
    v_pk_fma_f32 v[22:23], v[142:143], v[82:83], v[22:23] op_sel:[0,1,0] op_sel_hi:[1,1,1]
    ds_read_b128 v[64:67], v169
    ds_read_b128 v[80:83], v169
    s_set_gpr_idx_off
L_j4:
    s_waitcnt vmcnt(5)
    v_mfma_f32_16x16x16_bf16 v[128:131], v[160:161], v[112:113], 0
    v_readlane_b32 s66, v196, 4
    v_perm_b32 v162, v9, v9, v254
    v_mfma_f32_16x16x16_bf16 v[132:135], v[160:161], v[114:115], 0
    v_perm_b32 v163, v9, v9, v255
    s_and_b32 s61, s66, s49
    s_waitcnt vmcnt(4)
    buffer_load_dwordx4 v[104:107], v2, s[16:19], s61 offen
    v_mfma_f32_16x16x16_bf16 v[136:139], v[162:163], v[116:117], 0
    v_readlane_b32 s67, v196, 5
    v_cvt_pk_bf16_f32 v9, v150, v151
    v_mfma_f32_16x16x16_bf16 v[140:143], v[162:163], v[118:119], 0
    v_perm_b32 v160, v9, v9, v190
    v_perm_b32 v161, v9, v9, v191
    s_and_b32 s61, s67, s49
    s_set_gpr_idx_on s68, gpr_idx(SRC2,DST)
    buffer_load_dwordx4 v[108:111], v2, s[16:19], s61 offen
    v_pk_fma_f32 v[16:17], v[128:129], v[68:69], v[16:17] op_sel_hi:[1,0,1]
    v_pk_fma_f32 v[18:19], v[130:131], v[68:69], v[18:19] op_sel_hi:[1,0,1]
    v_pk_fma_f32 v[20:21], v[132:133], v[84:85], v[20:21] op_sel_hi:[1,0,1]
    v_pk_fma_f32 v[22:23], v[134:135], v[84:85], v[22:23] op_sel_hi:[1,0,1]
    s_set_gpr_idx_idx s69
    v_pk_fma_f32 v[16:17], v[136:137], v[68:69], v[16:17] op_sel:[0,1,0] op_sel_hi:[1,1,1]
    v_pk_fma_f32 v[18:19], v[138:139], v[68:69], v[18:19] op_sel:[0,1,0] op_sel_hi:[1,1,1]
    v_pk_fma_f32 v[20:21], v[140:141], v[84:85], v[20:21] op_sel:[0,1,0] op_sel_hi:[1,1,1]
    v_pk_fma_f32 v[22:23], v[142:143], v[84:85], v[22:23] op_sel:[0,1,0] op_sel_hi:[1,1,1]
    s_set_gpr_idx_off
L_j6:
    s_waitcnt vmcnt(5)
    v_mfma_f32_16x16x16_bf16 v[128:131], v[160:161], v[120:121], 0
    v_readlane_b32 s68, v196, 6
    v_perm_b32 v162, v9, v9, v254
    v_mfma_f32_16x16x16_bf16 v[132:135], v[160:161], v[122:123], 0
    v_perm_b32 v163, v9, v9, v255
    s_and_b32 s61, s68, s49
    s_waitcnt vmcnt(4)
    buffer_load_dwordx4 v[112:115], v2, s[16:19], s61 offen
    v_mfma_f32_16x16x16_bf16 v[136:139], v[162:163], v[124:125], 0
    v_readlane_b32 s69, v196, 7
    v_cvt_pk_bf16_f32 v9, v152, v153
    v_mfma_f32_16x16x16_bf16 v[140:143], v[162:163], v[126:127], 0
    v_perm_b32 v160, v9, v9, v190
    v_perm_b32 v161, v9, v9, v191
    s_and_b32 s61, s69, s49
    s_set_gpr_idx_on s70, gpr_idx(SRC2,DST)
    buffer_load_dwordx4 v[116:119], v2, s[16:19], s61 offen
    v_pk_fma_f32 v[16:17], v[128:129], v[70:71], v[16:17] op_sel_hi:[1,0,1]
    v_pk_fma_f32 v[18:19], v[130:131], v[70:71], v[18:19] op_sel_hi:[1,0,1]
    v_pk_fma_f32 v[20:21], v[132:133], v[86:87], v[20:21] op_sel_hi:[1,0,1]
    v_pk_fma_f32 v[22:23], v[134:135], v[86:87], v[22:23] op_sel_hi:[1,0,1]
    s_set_gpr_idx_idx s71
    v_pk_fma_f32 v[16:17], v[136:137], v[70:71], v[16:17] op_sel:[0,1,0] op_sel_hi:[1,1,1]
    v_pk_fma_f32 v[18:19], v[138:139], v[70:71], v[18:19] op_sel:[0,1,0] op_sel_hi:[1,1,1]
    v_pk_fma_f32 v[20:21], v[140:141], v[86:87], v[20:21] op_sel:[0,1,0] op_sel_hi:[1,1,1]
    v_pk_fma_f32 v[22:23], v[142:143], v[86:87], v[22:23] op_sel:[0,1,0] op_sel_hi:[1,1,1]
    ds_read_b128 v[68:71], v169
    ds_read_b128 v[84:87], v169
    s_set_gpr_idx_off
L_j8:
    s_waitcnt vmcnt(5)
    v_mfma_f32_16x16x16_bf16 v[128:131], v[160:161], v[96:97], 0
    v_readlane_b32 s70, v196, 8
    v_perm_b32 v162, v9, v9, v254
    v_mfma_f32_16x16x16_bf16 v[132:135], v[160:161], v[98:99], 0
    v_perm_b32 v163, v9, v9, v255
    s_and_b32 s61, s70, s49
    s_waitcnt vmcnt(4)
    buffer_load_dwordx4 v[120:123], v2, s[16:19], s61 offen
    v_mfma_f32_16x16x16_bf16 v[136:139], v[162:163], v[100:101], 0
    v_readlane_b32 s71, v196, 9
    v_cvt_pk_bf16_f32 v9, v154, v155
    v_mfma_f32_16x16x16_bf16 v[140:143], v[162:163], v[102:103], 0
    v_perm_b32 v160, v9, v9, v190
    v_perm_b32 v161, v9, v9, v191
    s_and_b32 s61, s71, s49
    s_set_gpr_idx_on s64, gpr_idx(SRC2,DST)
    buffer_load_dwordx4 v[124:127], v2, s[16:19], s61 offen
    v_pk_fma_f32 v[16:17], v[128:129], v[72:73], v[16:17] op_sel_hi:[1,0,1]
    v_pk_fma_f32 v[18:19], v[130:131], v[72:73], v[18:19] op_sel_hi:[1,0,1]
    v_pk_fma_f32 v[20:21], v[132:133], v[88:89], v[20:21] op_sel_hi:[1,0,1]
    v_pk_fma_f32 v[22:23], v[134:135], v[88:89], v[22:23] op_sel_hi:[1,0,1]
    s_set_gpr_idx_idx s65
    v_pk_fma_f32 v[16:17], v[136:137], v[72:73], v[16:17] op_sel:[0,1,0] op_sel_hi:[1,1,1]
    v_pk_fma_f32 v[18:19], v[138:139], v[72:73], v[18:19] op_sel:[0,1,0] op_sel_hi:[1,1,1]
    v_pk_fma_f32 v[20:21], v[140:141], v[88:89], v[20:21] op_sel:[0,1,0] op_sel_hi:[1,1,1]
    v_pk_fma_f32 v[22:23], v[142:143], v[88:89], v[22:23] op_sel:[0,1,0] op_sel_hi:[1,1,1]
    s_set_gpr_idx_off
L_j10:
    s_waitcnt vmcnt(5)
    v_mfma_f32_16x16x16_bf16 v[128:131], v[160:161], v[104:105], 0
    v_readlane_b32 s64, v196, 10
    v_perm_b32 v162, v9, v9, v254
    v_mfma_f32_16x16x16_bf16 v[132:135], v[160:161], v[106:107], 0
    v_perm_b32 v163, v9, v9, v255
    s_and_b32 s61, s64, s49
    s_waitcnt vmcnt(4)
    buffer_load_dwordx4 v[96:99], v2, s[16:19], s61 offen
    v_mfma_f32_16x16x16_bf16 v[136:139], v[162:163], v[108:109], 0
    v_readlane_b32 s65, v196, 11
    v_cvt_pk_bf16_f32 v9, v156, v157
    v_mfma_f32_16x16x16_bf16 v[140:143], v[162:163], v[110:111], 0
    v_perm_b32 v160, v9, v9, v190
    v_perm_b32 v161, v9, v9, v191
    s_and_b32 s61, s65, s49
    s_set_gpr_idx_on s66, gpr_idx(SRC2,DST)
    buffer_load_dwordx4 v[100:103], v2, s[16:19], s61 offen
    v_pk_fma_f32 v[16:17], v[128:129], v[74:75], v[16:17] op_sel_hi:[1,0,1]
    v_pk_fma_f32 v[18:19], v[130:131], v[74:75], v[18:19] op_sel_hi:[1,0,1]
    v_pk_fma_f32 v[20:21], v[132:133], v[90:91], v[20:21] op_sel_hi:[1,0,1]
    v_pk_fma_f32 v[22:23], v[134:135], v[90:91], v[22:23] op_sel_hi:[1,0,1]
    s_set_gpr_idx_idx s67
    v_pk_fma_f32 v[16:17], v[136:137], v[74:75], v[16:17] op_sel:[0,1,0] op_sel_hi:[1,1,1]
    v_pk_fma_f32 v[18:19], v[138:139], v[74:75], v[18:19] op_sel:[0,1,0] op_sel_hi:[1,1,1]
    v_pk_fma_f32 v[20:21], v[140:141], v[90:91], v[20:21] op_sel:[0,1,0] op_sel_hi:[1,1,1]
    v_pk_fma_f32 v[22:23], v[142:143], v[90:91], v[22:23] op_sel:[0,1,0] op_sel_hi:[1,1,1]
    ds_read_b128 v[72:75], v169
    ds_read_b128 v[88:91], v169
    s_set_gpr_idx_off
L_j12:
    s_waitcnt vmcnt(5)
    v_mfma_f32_16x16x16_bf16 v[128:131], v[160:161], v[112:113], 0
    v_readlane_b32 s66, v196, 12
    v_perm_b32 v162, v9, v9, v254
    v_mfma_f32_16x16x16_bf16 v[132:135], v[160:161], v[114:115], 0
    v_perm_b32 v163, v9, v9, v255
    s_and_b32 s61, s66, s49
    s_waitcnt vmcnt(4)
    buffer_load_dwordx4 v[104:107], v2, s[16:19], s61 offen
    v_mfma_f32_16x16x16_bf16 v[136:139], v[162:163], v[116:117], 0
    v_readlane_b32 s67, v196, 13
    v_cvt_pk_bf16_f32 v9, v158, v159
    v_mfma_f32_16x16x16_bf16 v[140:143], v[162:163], v[118:119], 0
    v_perm_b32 v160, v9, v9, v190
    v_perm_b32 v161, v9, v9, v191
    s_and_b32 s61, s67, s49
    s_set_gpr_idx_on s68, gpr_idx(SRC2,DST)
    buffer_load_dwordx4 v[108:111], v2, s[16:19], s61 offen
    v_pk_fma_f32 v[16:17], v[128:129], v[76:77], v[16:17] op_sel_hi:[1,0,1]
    v_pk_fma_f32 v[18:19], v[130:131], v[76:77], v[18:19] op_sel_hi:[1,0,1]
    v_pk_fma_f32 v[20:21], v[132:133], v[92:93], v[20:21] op_sel_hi:[1,0,1]
    v_pk_fma_f32 v[22:23], v[134:135], v[92:93], v[22:23] op_sel_hi:[1,0,1]
    s_set_gpr_idx_idx s69
    v_pk_fma_f32 v[16:17], v[136:137], v[76:77], v[16:17] op_sel:[0,1,0] op_sel_hi:[1,1,1]
    v_pk_fma_f32 v[18:19], v[138:139], v[76:77], v[18:19] op_sel:[0,1,0] op_sel_hi:[1,1,1]
    v_pk_fma_f32 v[20:21], v[140:141], v[92:93], v[20:21] op_sel:[0,1,0] op_sel_hi:[1,1,1]
    v_pk_fma_f32 v[22:23], v[142:143], v[92:93], v[22:23] op_sel:[0,1,0] op_sel_hi:[1,1,1]
    s_set_gpr_idx_off
L_j14:
    s_waitcnt vmcnt(5)
    v_mfma_f32_16x16x16_bf16 v[128:131], v[160:161], v[120:121], 0
    v_readlane_b32 s68, v196, 14
    v_perm_b32 v162, v9, v9, v254
    v_mfma_f32_16x16x16_bf16 v[132:135], v[160:161], v[122:123], 0
    v_perm_b32 v163, v9, v9, v255
    s_and_b32 s61, s68, s49
    s_waitcnt vmcnt(4)
    buffer_load_dwordx4 v[112:115], v2, s[16:19], s61 offen
    v_mfma_f32_16x16x16_bf16 v[136:139], v[162:163], v[124:125], 0
    v_readlane_b32 s69, v196, 15
    v_mfma_f32_16x16x16_bf16 v[140:143], v[162:163], v[126:127], 0
    s_and_b32 s61, s69, s49
    s_set_gpr_idx_on s70, gpr_idx(SRC2,DST)
    buffer_load_dwordx4 v[116:119], v2, s[16:19], s61 offen
    v_pk_fma_f32 v[16:17], v[128:129], v[78:79], v[16:17] op_sel_hi:[1,0,1]
    v_pk_fma_f32 v[18:19], v[130:131], v[78:79], v[18:19] op_sel_hi:[1,0,1]
    v_pk_fma_f32 v[20:21], v[132:133], v[94:95], v[20:21] op_sel_hi:[1,0,1]
    v_pk_fma_f32 v[22:23], v[134:135], v[94:95], v[22:23] op_sel_hi:[1,0,1]
    s_set_gpr_idx_idx s71
    s_sub_u32 s53, s53, 1
    v_pk_fma_f32 v[16:17], v[136:137], v[78:79], v[16:17] op_sel:[0,1,0] op_sel_hi:[1,1,1]
    v_pk_fma_f32 v[18:19], v[138:139], v[78:79], v[18:19] op_sel:[0,1,0] op_sel_hi:[1,1,1]
    v_pk_fma_f32 v[20:21], v[140:141], v[94:95], v[20:21] op_sel:[0,1,0] op_sel_hi:[1,1,1]
    v_pk_fma_f32 v[22:23], v[142:143], v[94:95], v[22:23] op_sel:[0,1,0] op_sel_hi:[1,1,1]
    ds_read_b128 v[76:79], v169
    ds_read_b128 v[92:95], v169
    s_set_gpr_idx_off
    s_cmp_lg_u32 s53, 0
    s_cbranch_scc1 L_loop
    s_waitcnt lgkmcnt(2)
    v_mfma_f32_4x4x4_16b_bf16 v[144:147], v[192:193], v[188:189], 0 cbsz:4 abid:0
    v_mfma_f32_4x4x4_16b_bf16 v[148:151], v[192:193], v[188:189], 0 cbsz:4 abid:2
    v_mfma_f32_4x4x4_16b_bf16 v[152:155], v[192:193], v[188:189], 0 cbsz:4 abid:4
    v_mfma_f32_4x4x4_16b_bf16 v[156:159], v[192:193], v[188:189], 0 cbsz:4 abid:6
    v_lshlrev_b32 v196, 3, v197
    v_and_b32 v196, s55, v196
    s_waitcnt lgkmcnt(0)
    v_smfmac_f32_32x32x32_bf16 v[64:79], v[164:167], v[172:179], v168
    v_cvt_pk_bf16_f32 v9, v144, v145
    v_perm_b32 v160, v9, v9, v190
    v_perm_b32 v161, v9, v9, v191
    v_smfmac_f32_32x32x32_bf16 v[80:95], v[164:167], v[180:187], v168
L_f0:
    s_waitcnt vmcnt(5)
    v_mfma_f32_16x16x16_bf16 v[128:131], v[160:161], v[96:97], 0
    v_readlane_b32 s70, v196, 0
    v_perm_b32 v162, v9, v9, v254
    v_mfma_f32_16x16x16_bf16 v[132:135], v[160:161], v[98:99], 0
    v_perm_b32 v163, v9, v9, v255
    s_and_b32 s61, s70, s49
    s_waitcnt vmcnt(4)
    buffer_load_dwordx4 v[120:123], v2, s[16:19], s61 offen
    v_mfma_f32_16x16x16_bf16 v[136:139], v[162:163], v[100:101], 0
    v_readlane_b32 s71, v196, 1
    v_cvt_pk_bf16_f32 v9, v146, v147
    v_mfma_f32_16x16x16_bf16 v[140:143], v[162:163], v[102:103], 0
    v_perm_b32 v160, v9, v9, v190
    v_perm_b32 v161, v9, v9, v191
    s_and_b32 s61, s71, s49
    s_set_gpr_idx_on s64, gpr_idx(SRC2,DST)
    buffer_load_dwordx4 v[124:127], v2, s[16:19], s61 offen
    v_pk_fma_f32 v[16:17], v[128:129], v[64:65], v[16:17] op_sel_hi:[1,0,1]
    v_pk_fma_f32 v[18:19], v[130:131], v[64:65], v[18:19] op_sel_hi:[1,0,1]
    v_pk_fma_f32 v[20:21], v[132:133], v[80:81], v[20:21] op_sel_hi:[1,0,1]
    v_pk_fma_f32 v[22:23], v[134:135], v[80:81], v[22:23] op_sel_hi:[1,0,1]
    s_set_gpr_idx_idx s65
    v_pk_fma_f32 v[16:17], v[136:137], v[64:65], v[16:17] op_sel:[0,1,0] op_sel_hi:[1,1,1]
    v_pk_fma_f32 v[18:19], v[138:139], v[64:65], v[18:19] op_sel:[0,1,0] op_sel_hi:[1,1,1]
    v_pk_fma_f32 v[20:21], v[140:141], v[80:81], v[20:21] op_sel:[0,1,0] op_sel_hi:[1,1,1]
    v_pk_fma_f32 v[22:23], v[142:143], v[80:81], v[22:23] op_sel:[0,1,0] op_sel_hi:[1,1,1]
    s_set_gpr_idx_off
    s_waitcnt vmcnt(5)
    v_mfma_f32_16x16x16_bf16 v[128:131], v[160:161], v[104:105], 0
    v_readlane_b32 s64, v196, 2
    v_perm_b32 v162, v9, v9, v254
    v_mfma_f32_16x16x16_bf16 v[132:135], v[160:161], v[106:107], 0
    v_perm_b32 v163, v9, v9, v255
    s_and_b32 s61, s64, s49
    s_waitcnt vmcnt(4)
    buffer_load_dwordx4 v[96:99], v2, s[16:19], s61 offen
    v_mfma_f32_16x16x16_bf16 v[136:139], v[162:163], v[108:109], 0
    v_readlane_b32 s65, v196, 3
    v_cvt_pk_bf16_f32 v9, v148, v149
    v_mfma_f32_16x16x16_bf16 v[140:143], v[162:163], v[110:111], 0
    v_perm_b32 v160, v9, v9, v190
    v_perm_b32 v161, v9, v9, v191
    v_lshlrev_b32 v12, 2, v1
    s_lshl_b32 s61, s3, 7
    v_and_b32 v205, 0x7380, v205
    v_xor_b32 v205, s61, v205
    v_alignbit_b32 v205, v205, v205, 12
    v_cmp_eq_u32 s[80:81], 0, v205
    v_cmp_eq_u32 s[82:83], 1, v205
    v_cmp_eq_u32 s[84:85], 2, v205
    v_cmp_eq_u32 s[96:97], 3, v205
    v_cmp_eq_u32 vcc, 4, v205
    s_ff1_i32_b64 s56, s[80:81]
    s_mul_i32 s56, s56, 1152
    v_add_u32 v208, s56, v12
    s_ff1_i32_b64 s57, s[82:83]
    s_mul_i32 s57, s57, 1152
    v_add_u32 v209, s57, v12
    s_ff1_i32_b64 s58, s[84:85]
    s_mul_i32 s58, s58, 1152
    v_add_u32 v210, s58, v12
    s_ff1_i32_b64 s59, s[96:97]
    s_mul_i32 s59, s59, 1152
    v_add_u32 v211, s59, v12
    s_ff1_i32_b64 s60, vcc
    s_mul_i32 s60, s60, 1152
    v_add_u32 v212, s60, v12
    s_and_b32 s61, s65, s49
    s_set_gpr_idx_on s66, gpr_idx(SRC2,DST)
    buffer_load_dwordx4 v[100:103], v2, s[16:19], s61 offen
    v_pk_fma_f32 v[16:17], v[128:129], v[66:67], v[16:17] op_sel_hi:[1,0,1]
    v_pk_fma_f32 v[18:19], v[130:131], v[66:67], v[18:19] op_sel_hi:[1,0,1]
    v_pk_fma_f32 v[20:21], v[132:133], v[82:83], v[20:21] op_sel_hi:[1,0,1]
    v_pk_fma_f32 v[22:23], v[134:135], v[82:83], v[22:23] op_sel_hi:[1,0,1]
    s_set_gpr_idx_idx s67
    v_pk_fma_f32 v[16:17], v[136:137], v[66:67], v[16:17] op_sel:[0,1,0] op_sel_hi:[1,1,1]
    v_pk_fma_f32 v[18:19], v[138:139], v[66:67], v[18:19] op_sel:[0,1,0] op_sel_hi:[1,1,1]
    v_pk_fma_f32 v[20:21], v[140:141], v[82:83], v[20:21] op_sel:[0,1,0] op_sel_hi:[1,1,1]
    v_pk_fma_f32 v[22:23], v[142:143], v[82:83], v[22:23] op_sel:[0,1,0] op_sel_hi:[1,1,1]
    s_set_gpr_idx_off
    s_waitcnt vmcnt(5)
    v_mfma_f32_16x16x16_bf16 v[128:131], v[160:161], v[112:113], 0
    v_readlane_b32 s66, v196, 4
    v_perm_b32 v162, v9, v9, v254
    v_mfma_f32_16x16x16_bf16 v[132:135], v[160:161], v[114:115], 0
    v_perm_b32 v163, v9, v9, v255
    s_and_b32 s61, s66, s49
    s_waitcnt vmcnt(4)
    buffer_load_dwordx4 v[104:107], v2, s[16:19], s61 offen
    v_mfma_f32_16x16x16_bf16 v[136:139], v[162:163], v[116:117], 0
    v_readlane_b32 s67, v196, 5
    v_cvt_pk_bf16_f32 v9, v150, v151
    v_mfma_f32_16x16x16_bf16 v[140:143], v[162:163], v[118:119], 0
    v_perm_b32 v160, v9, v9, v190
    v_perm_b32 v161, v9, v9, v191
    s_and_b32 s61, s67, s49
    s_set_gpr_idx_on s68, gpr_idx(SRC2,DST)
    buffer_load_dwordx4 v[108:111], v2, s[16:19], s61 offen
    v_pk_fma_f32 v[16:17], v[128:129], v[68:69], v[16:17] op_sel_hi:[1,0,1]
    v_pk_fma_f32 v[18:19], v[130:131], v[68:69], v[18:19] op_sel_hi:[1,0,1]
    v_pk_fma_f32 v[20:21], v[132:133], v[84:85], v[20:21] op_sel_hi:[1,0,1]
    v_pk_fma_f32 v[22:23], v[134:135], v[84:85], v[22:23] op_sel_hi:[1,0,1]
    s_set_gpr_idx_idx s69
    v_pk_fma_f32 v[16:17], v[136:137], v[68:69], v[16:17] op_sel:[0,1,0] op_sel_hi:[1,1,1]
    v_pk_fma_f32 v[18:19], v[138:139], v[68:69], v[18:19] op_sel:[0,1,0] op_sel_hi:[1,1,1]
    v_pk_fma_f32 v[20:21], v[140:141], v[84:85], v[20:21] op_sel:[0,1,0] op_sel_hi:[1,1,1]
    v_pk_fma_f32 v[22:23], v[142:143], v[84:85], v[22:23] op_sel:[0,1,0] op_sel_hi:[1,1,1]
    s_set_gpr_idx_off
    s_waitcnt vmcnt(5)
    v_mfma_f32_16x16x16_bf16 v[128:131], v[160:161], v[120:121], 0
    v_readlane_b32 s68, v196, 6
    v_perm_b32 v162, v9, v9, v254
    v_mfma_f32_16x16x16_bf16 v[132:135], v[160:161], v[122:123], 0
    v_perm_b32 v163, v9, v9, v255
    s_and_b32 s61, s68, s49
    s_waitcnt vmcnt(4)
    buffer_load_dwordx4 v[112:115], v2, s[16:19], s61 offen
    v_mfma_f32_16x16x16_bf16 v[136:139], v[162:163], v[124:125], 0
    v_readlane_b32 s69, v196, 7
    v_cvt_pk_bf16_f32 v9, v152, v153
    v_mfma_f32_16x16x16_bf16 v[140:143], v[162:163], v[126:127], 0
    v_perm_b32 v160, v9, v9, v190
    v_perm_b32 v161, v9, v9, v191
    s_and_b32 s61, s69, s49
    s_set_gpr_idx_on s70, gpr_idx(SRC2,DST)
    buffer_load_dwordx4 v[116:119], v2, s[16:19], s61 offen
    v_pk_fma_f32 v[16:17], v[128:129], v[70:71], v[16:17] op_sel_hi:[1,0,1]
    v_pk_fma_f32 v[18:19], v[130:131], v[70:71], v[18:19] op_sel_hi:[1,0,1]
    v_pk_fma_f32 v[20:21], v[132:133], v[86:87], v[20:21] op_sel_hi:[1,0,1]
    v_pk_fma_f32 v[22:23], v[134:135], v[86:87], v[22:23] op_sel_hi:[1,0,1]
    s_set_gpr_idx_idx s71
    v_pk_fma_f32 v[16:17], v[136:137], v[70:71], v[16:17] op_sel:[0,1,0] op_sel_hi:[1,1,1]
    v_pk_fma_f32 v[18:19], v[138:139], v[70:71], v[18:19] op_sel:[0,1,0] op_sel_hi:[1,1,1]
    v_pk_fma_f32 v[20:21], v[140:141], v[86:87], v[20:21] op_sel:[0,1,0] op_sel_hi:[1,1,1]
    v_pk_fma_f32 v[22:23], v[142:143], v[86:87], v[22:23] op_sel:[0,1,0] op_sel_hi:[1,1,1]
    ds_read_b128 v[144:147], v215 offset:14336
    ds_read_b128 v[148:151], v215 offset:15360
    s_set_gpr_idx_off
    s_waitcnt vmcnt(5)
    v_mfma_f32_16x16x16_bf16 v[128:131], v[160:161], v[96:97], 0
    v_readlane_b32 s70, v196, 8
    v_perm_b32 v162, v9, v9, v254
    v_mfma_f32_16x16x16_bf16 v[132:135], v[160:161], v[98:99], 0
    v_perm_b32 v163, v9, v9, v255
    s_and_b32 s61, s70, s49
    s_waitcnt vmcnt(4)
    buffer_load_dwordx4 v[120:123], v2, s[16:19], s61 offen
    v_mfma_f32_16x16x16_bf16 v[136:139], v[162:163], v[100:101], 0
    v_readlane_b32 s71, v196, 9
    v_cvt_pk_bf16_f32 v9, v154, v155
    v_mfma_f32_16x16x16_bf16 v[140:143], v[162:163], v[102:103], 0
    v_perm_b32 v160, v9, v9, v190
    v_perm_b32 v161, v9, v9, v191
    s_and_b32 s61, s71, s49
    s_set_gpr_idx_on s64, gpr_idx(SRC2,DST)
    buffer_load_dwordx4 v[124:127], v2, s[16:19], s61 offen
    v_pk_fma_f32 v[16:17], v[128:129], v[72:73], v[16:17] op_sel_hi:[1,0,1]
    v_pk_fma_f32 v[18:19], v[130:131], v[72:73], v[18:19] op_sel_hi:[1,0,1]
    v_pk_fma_f32 v[20:21], v[132:133], v[88:89], v[20:21] op_sel_hi:[1,0,1]
    v_pk_fma_f32 v[22:23], v[134:135], v[88:89], v[22:23] op_sel_hi:[1,0,1]
    s_set_gpr_idx_idx s65
    v_pk_fma_f32 v[16:17], v[136:137], v[72:73], v[16:17] op_sel:[0,1,0] op_sel_hi:[1,1,1]
    v_pk_fma_f32 v[18:19], v[138:139], v[72:73], v[18:19] op_sel:[0,1,0] op_sel_hi:[1,1,1]
    v_pk_fma_f32 v[20:21], v[140:141], v[88:89], v[20:21] op_sel:[0,1,0] op_sel_hi:[1,1,1]
    v_pk_fma_f32 v[22:23], v[142:143], v[88:89], v[22:23] op_sel:[0,1,0] op_sel_hi:[1,1,1]
    ds_read_b128 v[96:99], v215 offset:6144
    ds_read_b128 v[100:103], v215 offset:7168
    s_set_gpr_idx_off
    s_waitcnt vmcnt(5)
    v_mfma_f32_16x16x16_bf16 v[128:131], v[160:161], v[104:105], 0
    v_perm_b32 v162, v9, v9, v254
    v_mfma_f32_16x16x16_bf16 v[132:135], v[160:161], v[106:107], 0
    v_perm_b32 v163, v9, v9, v255
    s_waitcnt vmcnt(4)
    s_nop 0
    v_mfma_f32_16x16x16_bf16 v[136:139], v[162:163], v[108:109], 0
    v_cvt_pk_bf16_f32 v9, v156, v157
    v_mfma_f32_16x16x16_bf16 v[140:143], v[162:163], v[110:111], 0
    v_perm_b32 v160, v9, v9, v190
    v_perm_b32 v161, v9, v9, v191
    s_set_gpr_idx_on s66, gpr_idx(SRC2,DST)
    v_pk_fma_f32 v[16:17], v[128:129], v[74:75], v[16:17] op_sel_hi:[1,0,1]
    v_pk_fma_f32 v[18:19], v[130:131], v[74:75], v[18:19] op_sel_hi:[1,0,1]
    v_pk_fma_f32 v[20:21], v[132:133], v[90:91], v[20:21] op_sel_hi:[1,0,1]
    v_pk_fma_f32 v[22:23], v[134:135], v[90:91], v[22:23] op_sel_hi:[1,0,1]
    s_set_gpr_idx_idx s67
    v_pk_fma_f32 v[16:17], v[136:137], v[74:75], v[16:17] op_sel:[0,1,0] op_sel_hi:[1,1,1]
    v_pk_fma_f32 v[18:19], v[138:139], v[74:75], v[18:19] op_sel:[0,1,0] op_sel_hi:[1,1,1]
    v_pk_fma_f32 v[20:21], v[140:141], v[90:91], v[20:21] op_sel:[0,1,0] op_sel_hi:[1,1,1]
    v_pk_fma_f32 v[22:23], v[142:143], v[90:91], v[22:23] op_sel:[0,1,0] op_sel_hi:[1,1,1]
    ds_read_b128 v[104:107], v215 offset:8192
    ds_read_b128 v[108:111], v215 offset:9216
    s_set_gpr_idx_off
    s_waitcnt vmcnt(3)
    v_mfma_f32_16x16x16_bf16 v[128:131], v[160:161], v[112:113], 0
    v_perm_b32 v162, v9, v9, v254
    v_mfma_f32_16x16x16_bf16 v[132:135], v[160:161], v[114:115], 0
    v_perm_b32 v163, v9, v9, v255
    s_waitcnt vmcnt(2)
    s_nop 0
    v_mfma_f32_16x16x16_bf16 v[136:139], v[162:163], v[116:117], 0
    v_cvt_pk_bf16_f32 v9, v158, v159
    v_mfma_f32_16x16x16_bf16 v[140:143], v[162:163], v[118:119], 0
    v_perm_b32 v160, v9, v9, v190
    v_perm_b32 v161, v9, v9, v191
    s_set_gpr_idx_on s68, gpr_idx(SRC2,DST)
    v_pk_fma_f32 v[16:17], v[128:129], v[76:77], v[16:17] op_sel_hi:[1,0,1]
    v_pk_fma_f32 v[18:19], v[130:131], v[76:77], v[18:19] op_sel_hi:[1,0,1]
    v_pk_fma_f32 v[20:21], v[132:133], v[92:93], v[20:21] op_sel_hi:[1,0,1]
    v_pk_fma_f32 v[22:23], v[134:135], v[92:93], v[22:23] op_sel_hi:[1,0,1]
    s_set_gpr_idx_idx s69
    v_pk_fma_f32 v[16:17], v[136:137], v[76:77], v[16:17] op_sel:[0,1,0] op_sel_hi:[1,1,1]
    v_pk_fma_f32 v[18:19], v[138:139], v[76:77], v[18:19] op_sel:[0,1,0] op_sel_hi:[1,1,1]
    v_pk_fma_f32 v[20:21], v[140:141], v[92:93], v[20:21] op_sel:[0,1,0] op_sel_hi:[1,1,1]
    v_pk_fma_f32 v[22:23], v[142:143], v[92:93], v[22:23] op_sel:[0,1,0] op_sel_hi:[1,1,1]
    ds_read_b128 v[112:115], v215 offset:10240
    ds_read_b128 v[116:119], v215 offset:11264
    s_set_gpr_idx_off
    s_waitcnt vmcnt(1)
    v_mfma_f32_16x16x16_bf16 v[128:131], v[160:161], v[120:121], 0
    v_perm_b32 v162, v9, v9, v254
    v_mfma_f32_16x16x16_bf16 v[132:135], v[160:161], v[122:123], 0
    v_perm_b32 v163, v9, v9, v255
    s_waitcnt vmcnt(0)
    s_nop 0
    v_mfma_f32_16x16x16_bf16 v[136:139], v[162:163], v[124:125], 0
    v_mfma_f32_16x16x16_bf16 v[140:143], v[162:163], v[126:127], 0
    s_set_gpr_idx_on s70, gpr_idx(SRC2,DST)
    v_pk_fma_f32 v[16:17], v[128:129], v[78:79], v[16:17] op_sel_hi:[1,0,1]
    v_pk_fma_f32 v[18:19], v[130:131], v[78:79], v[18:19] op_sel_hi:[1,0,1]
    v_pk_fma_f32 v[20:21], v[132:133], v[94:95], v[20:21] op_sel_hi:[1,0,1]
    v_pk_fma_f32 v[22:23], v[134:135], v[94:95], v[22:23] op_sel_hi:[1,0,1]
    s_set_gpr_idx_idx s71
    s_nop 0
    v_pk_fma_f32 v[16:17], v[136:137], v[78:79], v[16:17] op_sel:[0,1,0] op_sel_hi:[1,1,1]
    v_pk_fma_f32 v[18:19], v[138:139], v[78:79], v[18:19] op_sel:[0,1,0] op_sel_hi:[1,1,1]
    v_pk_fma_f32 v[20:21], v[140:141], v[94:95], v[20:21] op_sel:[0,1,0] op_sel_hi:[1,1,1]
    v_pk_fma_f32 v[22:23], v[142:143], v[94:95], v[22:23] op_sel:[0,1,0] op_sel_hi:[1,1,1]
    ds_read_b128 v[120:123], v215 offset:12288
    ds_read_b128 v[124:127], v215 offset:13312
    s_set_gpr_idx_off
L_swept:
    s_add_u32 s48, s48, 224
    s_cmp_lt_u32 s48, s47
    s_cbranch_scc1 L_again
    s_setprio 0
    v_cvt_pk_bf16_f32 v64, v16, v20
    v_cvt_pk_bf16_f32 v65, v17, v21
    v_cvt_pk_bf16_f32 v66, v18, v22
    v_cvt_pk_bf16_f32 v67, v19, v23
    ds_write2_b32 v208, v64, v65 offset0:0 offset1:72
    ds_write2_b32 v208, v66, v67 offset0:144 offset1:216
    v_cvt_pk_bf16_f32 v68, v24, v28
    v_cvt_pk_bf16_f32 v69, v25, v29
    v_cvt_pk_bf16_f32 v70, v26, v30
    v_cvt_pk_bf16_f32 v71, v27, v31
    ds_write2_b32 v209, v68, v69 offset0:0 offset1:72
    ds_write2_b32 v209, v70, v71 offset0:144 offset1:216
    v_cvt_pk_bf16_f32 v72, v32, v36
    v_cvt_pk_bf16_f32 v73, v33, v37
    v_cvt_pk_bf16_f32 v74, v34, v38
    v_cvt_pk_bf16_f32 v75, v35, v39
    ds_write2_b32 v210, v72, v73 offset0:0 offset1:72
    ds_write2_b32 v210, v74, v75 offset0:144 offset1:216
    v_cvt_pk_bf16_f32 v76, v40, v44
    v_cvt_pk_bf16_f32 v77, v41, v45
    v_cvt_pk_bf16_f32 v78, v42, v46
    v_cvt_pk_bf16_f32 v79, v43, v47
    ds_write2_b32 v211, v76, v77 offset0:0 offset1:72
    ds_write2_b32 v211, v78, v79 offset0:144 offset1:216
    v_cvt_pk_bf16_f32 v80, v48, v52
    v_cvt_pk_bf16_f32 v81, v49, v53
    v_cvt_pk_bf16_f32 v82, v50, v54
    v_cvt_pk_bf16_f32 v83, v51, v55
    ds_write2_b32 v212, v80, v81 offset0:0 offset1:72
    ds_write2_b32 v212, v82, v83 offset0:144 offset1:216
    s_waitcnt lgkmcnt(0)
    s_barrier
    ds_read_b128 v[16:19], v213 offset:0
    ds_read_b128 v[20:23], v213 offset:64
    ds_read_b128 v[24:27], v213 offset:128
    ds_read_b128 v[28:31], v213 offset:192
    s_waitcnt lgkmcnt(3)
    v_mfma_f32_16x16x32_bf16 v[160:163], v[16:19], v[216:219], 0
    v_mfma_f32_16x16x32_bf16 v[164:167], v[16:19], v[220:223], 0
    v_mfma_f32_16x16x32_bf16 v[168:171], v[16:19], v[224:227], 0
    v_mfma_f32_16x16x32_bf16 v[172:175], v[16:19], v[228:231], 0
    ds_read_b128 v[32:35], v213 offset:4608
    ds_read_b128 v[36:39], v213 offset:4672
    ds_read_b128 v[40:43], v213 offset:4736
    ds_read_b128 v[44:47], v213 offset:4800
    s_waitcnt lgkmcnt(6)
    v_mfma_f32_16x16x32_bf16 v[160:163], v[20:23], v[232:235], v[160:163]
    v_mfma_f32_16x16x32_bf16 v[164:167], v[20:23], v[236:239], v[164:167]
    v_mfma_f32_16x16x32_bf16 v[168:171], v[20:23], v[96:99], v[168:171]
    v_mfma_f32_16x16x32_bf16 v[172:175], v[20:23], v[100:103], v[172:175]
    ds_read_b128 v[48:51], v213 offset:9216
    ds_read_b128 v[52:55], v213 offset:9280
    ds_read_b128 v[56:59], v213 offset:9344
    ds_read_b128 v[60:63], v213 offset:9408
    s_waitcnt lgkmcnt(9)
    v_mfma_f32_16x16x32_bf16 v[160:163], v[24:27], v[104:107], v[160:163]
    v_mfma_f32_16x16x32_bf16 v[164:167], v[24:27], v[108:111], v[164:167]
    v_mfma_f32_16x16x32_bf16 v[168:171], v[24:27], v[112:115], v[168:171]
    v_mfma_f32_16x16x32_bf16 v[172:175], v[24:27], v[116:119], v[172:175]
    s_waitcnt lgkmcnt(8)
    v_mfma_f32_16x16x32_bf16 v[160:163], v[28:31], v[120:123], v[160:163]
    v_mfma_f32_16x16x32_bf16 v[164:167], v[28:31], v[124:127], v[164:167]
    v_mfma_f32_16x16x32_bf16 v[168:171], v[28:31], v[144:147], v[168:171]
    v_mfma_f32_16x16x32_bf16 v[172:175], v[28:31], v[148:151], v[172:175]
    s_waitcnt lgkmcnt(4)
    v_mfma_f32_16x16x32_bf16 v[176:179], v[32:35], v[216:219], 0
    v_mfma_f32_16x16x32_bf16 v[180:183], v[32:35], v[220:223], 0
    v_mfma_f32_16x16x32_bf16 v[184:187], v[32:35], v[224:227], 0
    v_mfma_f32_16x16x32_bf16 v[188:191], v[32:35], v[228:231], 0
    v_mfma_f32_16x16x32_bf16 v[176:179], v[36:39], v[232:235], v[176:179]
    v_cvt_pk_bf16_f32 v64, v160, v164
    v_cvt_pk_bf16_f32 v80, v160, v164
    v_mfma_f32_16x16x32_bf16 v[180:183], v[36:39], v[236:239], v[180:183]
    v_cvt_pk_bf16_f32 v66, v162, v166
    v_cvt_pk_bf16_f32 v65, v168, v172
    v_mfma_f32_16x16x32_bf16 v[184:187], v[36:39], v[96:99], v[184:187]
    v_cvt_pk_bf16_f32 v81, v168, v172
    v_cvt_pk_bf16_f32 v67, v170, v174
    v_mfma_f32_16x16x32_bf16 v[188:191], v[36:39], v[100:103], v[188:191]
    v_mov_b32_dpp v64, v66 row_ror:8 row_mask:0xf bank_mask:0xc
    v_mov_b32_dpp v65, v67 row_ror:8 row_mask:0xf bank_mask:0xc
    v_mfma_f32_16x16x32_bf16 v[176:179], v[40:43], v[104:107], v[176:179]
    v_mov_b32_dpp v66, v80 row_ror:8 row_mask:0xf bank_mask:0x3
    v_mov_b32_dpp v67, v81 row_ror:8 row_mask:0xf bank_mask:0x3
    v_mfma_f32_16x16x32_bf16 v[180:183], v[40:43], v[108:111], v[180:183]
    buffer_store_dwordx4 v[64:67], v214, s[40:43], s87 offen offset:0 sc1
    v_cvt_pk_bf16_f32 v68, v161, v165
    v_mfma_f32_16x16x32_bf16 v[184:187], v[40:43], v[112:115], v[184:187]
    v_cvt_pk_bf16_f32 v82, v161, v165
    v_cvt_pk_bf16_f32 v70, v163, v167
    v_mfma_f32_16x16x32_bf16 v[188:191], v[40:43], v[116:119], v[188:191]
    v_cvt_pk_bf16_f32 v69, v169, v173
    v_cvt_pk_bf16_f32 v83, v169, v173
    v_mfma_f32_16x16x32_bf16 v[176:179], v[44:47], v[120:123], v[176:179]
    v_cvt_pk_bf16_f32 v71, v171, v175
    v_mov_b32_dpp v68, v70 row_ror:8 row_mask:0xf bank_mask:0xc
    v_mfma_f32_16x16x32_bf16 v[180:183], v[44:47], v[124:127], v[180:183]
    v_mov_b32_dpp v69, v71 row_ror:8 row_mask:0xf bank_mask:0xc
    v_mov_b32_dpp v70, v82 row_ror:8 row_mask:0xf bank_mask:0x3
    v_mfma_f32_16x16x32_bf16 v[184:187], v[44:47], v[144:147], v[184:187]
    v_mov_b32_dpp v71, v83 row_ror:8 row_mask:0xf bank_mask:0x3
    buffer_store_dwordx4 v[68:71], v214, s[40:43], s87 offen offset:256 sc1
    v_mfma_f32_16x16x32_bf16 v[188:191], v[44:47], v[148:151], v[188:191]
    s_add_u32 s87, s87, 4096
    s_cmp_ge_u32 s3, 4
    s_cbranch_scc1 L_two
    s_waitcnt lgkmcnt(0)
    v_mfma_f32_16x16x32_bf16 v[160:163], v[48:51], v[216:219], 0
    v_mfma_f32_16x16x32_bf16 v[164:167], v[48:51], v[220:223], 0
    v_mfma_f32_16x16x32_bf16 v[168:171], v[48:51], v[224:227], 0
    v_mfma_f32_16x16x32_bf16 v[172:175], v[48:51], v[228:231], 0
    v_mfma_f32_16x16x32_bf16 v[160:163], v[52:55], v[232:235], v[160:163]
    v_cvt_pk_bf16_f32 v72, v176, v180
    v_cvt_pk_bf16_f32 v80, v176, v180
    v_mfma_f32_16x16x32_bf16 v[164:167], v[52:55], v[236:239], v[164:167]
    v_cvt_pk_bf16_f32 v74, v178, v182
    v_cvt_pk_bf16_f32 v73, v184, v188
    v_mfma_f32_16x16x32_bf16 v[168:171], v[52:55], v[96:99], v[168:171]
    v_cvt_pk_bf16_f32 v81, v184, v188
    v_cvt_pk_bf16_f32 v75, v186, v190
    v_mfma_f32_16x16x32_bf16 v[172:175], v[52:55], v[100:103], v[172:175]
    v_mov_b32_dpp v72, v74 row_ror:8 row_mask:0xf bank_mask:0xc
    v_mov_b32_dpp v73, v75 row_ror:8 row_mask:0xf bank_mask:0xc
    v_mfma_f32_16x16x32_bf16 v[160:163], v[56:59], v[104:107], v[160:163]
    v_mov_b32_dpp v74, v80 row_ror:8 row_mask:0xf bank_mask:0x3
    v_mov_b32_dpp v75, v81 row_ror:8 row_mask:0xf bank_mask:0x3
    v_mfma_f32_16x16x32_bf16 v[164:167], v[56:59], v[108:111], v[164:167]
    buffer_store_dwordx4 v[72:75], v214, s[40:43], s87 offen offset:0 sc1
    v_cvt_pk_bf16_f32 v76, v177, v181
    v_mfma_f32_16x16x32_bf16 v[168:171], v[56:59], v[112:115], v[168:171]
    v_cvt_pk_bf16_f32 v82, v177, v181
    v_cvt_pk_bf16_f32 v78, v179, v183
    v_mfma_f32_16x16x32_bf16 v[172:175], v[56:59], v[116:119], v[172:175]
    v_cvt_pk_bf16_f32 v77, v185, v189
    v_cvt_pk_bf16_f32 v83, v185, v189
    v_mfma_f32_16x16x32_bf16 v[160:163], v[60:63], v[120:123], v[160:163]
    v_cvt_pk_bf16_f32 v79, v187, v191
    v_mov_b32_dpp v76, v78 row_ror:8 row_mask:0xf bank_mask:0xc
    v_mfma_f32_16x16x32_bf16 v[164:167], v[60:63], v[124:127], v[164:167]
    v_mov_b32_dpp v77, v79 row_ror:8 row_mask:0xf bank_mask:0xc
    v_mov_b32_dpp v78, v82 row_ror:8 row_mask:0xf bank_mask:0x3
    v_mfma_f32_16x16x32_bf16 v[168:171], v[60:63], v[144:147], v[168:171]
    v_mov_b32_dpp v79, v83 row_ror:8 row_mask:0xf bank_mask:0x3
    buffer_store_dwordx4 v[76:79], v214, s[40:43], s87 offen offset:256 sc1
    v_mfma_f32_16x16x32_bf16 v[172:175], v[60:63], v[148:151], v[172:175]
    s_add_u32 s87, s87, 4096
    s_nop 0
    v_cvt_pk_bf16_f32 v64, v160, v164
    v_cvt_pk_bf16_f32 v80, v160, v164
    v_cvt_pk_bf16_f32 v66, v162, v166
    s_nop 2
    v_cvt_pk_bf16_f32 v65, v168, v172
    v_cvt_pk_bf16_f32 v81, v168, v172
    v_cvt_pk_bf16_f32 v67, v170, v174
    v_mov_b32_dpp v64, v66 row_ror:8 row_mask:0xf bank_mask:0xc
    s_nop 0
    v_mov_b32_dpp v65, v67 row_ror:8 row_mask:0xf bank_mask:0xc
    v_mov_b32_dpp v66, v80 row_ror:8 row_mask:0xf bank_mask:0x3
    v_mov_b32_dpp v67, v81 row_ror:8 row_mask:0xf bank_mask:0x3
    buffer_store_dwordx4 v[64:67], v214, s[40:43], s87 offen offset:0 sc1
    v_cvt_pk_bf16_f32 v68, v161, v165
    v_cvt_pk_bf16_f32 v82, v161, v165
    v_cvt_pk_bf16_f32 v70, v163, v167
    v_cvt_pk_bf16_f32 v69, v169, v173
    v_cvt_pk_bf16_f32 v83, v169, v173
    v_cvt_pk_bf16_f32 v71, v171, v175
    v_mov_b32_dpp v68, v70 row_ror:8 row_mask:0xf bank_mask:0xc
    s_nop 0
    v_mov_b32_dpp v69, v71 row_ror:8 row_mask:0xf bank_mask:0xc
    v_mov_b32_dpp v70, v82 row_ror:8 row_mask:0xf bank_mask:0x3
    v_mov_b32_dpp v71, v83 row_ror:8 row_mask:0xf bank_mask:0x3
    buffer_store_dwordx4 v[68:71], v214, s[40:43], s87 offen offset:256 sc1
    s_add_u32 s87, s87, 4096
L_stored:
L_done:
    s_endpgm
L_again:
    s_waitcnt vmcnt(0) lgkmcnt(0)
    s_barrier
    v_lshlrev_b32 v11, 2, v0
    v_mov_b32 v12, 0x00700000
    v_mov_b32 v13, 0
    ds_write_b32 v11, v12 offset:0
    ds_write_b32 v11, v12 offset:2048
    ds_write_b32 v11, v12 offset:4096
    ds_write_b32 v11, v12 offset:6144
    ds_write_b32 v11, v13 offset:8192
    ds_write_b32 v11, v13 offset:10240
    ds_write_b32 v11, v13 offset:12288
    v_mov_b32 v64, 0
    v_mov_b32 v65, 0
    v_mov_b32 v66, 0
    v_mov_b32 v67, 0
    v_mov_b32 v68, 0
    v_mov_b32 v69, 0
    v_mov_b32 v70, 0
    v_mov_b32 v71, 0
    v_mov_b32 v72, 0
    v_mov_b32 v73, 0
    v_mov_b32 v74, 0
    v_mov_b32 v75, 0
    v_mov_b32 v76, 0
    v_mov_b32 v77, 0
    v_mov_b32 v78, 0
    v_mov_b32 v79, 0
    v_mov_b32 v80, 0
    v_mov_b32 v81, 0
    v_mov_b32 v82, 0
    v_mov_b32 v83, 0
    v_mov_b32 v84, 0
    v_mov_b32 v85, 0
    v_mov_b32 v86, 0
    v_mov_b32 v87, 0
    v_mov_b32 v88, 0
    v_mov_b32 v89, 0
    v_mov_b32 v90, 0
    v_mov_b32 v91, 0
    v_mov_b32 v92, 0
    v_mov_b32 v93, 0
    v_mov_b32 v94, 0
    v_mov_b32 v95, 0
    v_add_u32 v3, v3, v4
    v_subrev_u32 v3, 224, v3
    v_max_i32 v3, 0, v3
    v_subrev_u32 v4, 224, v4
    v_max_i32 v4, 0, v4
    v_sub_u32 v3, v3, v4
    v_add_u32 v5, 224, v5
    s_sub_i32 s95, s95, 224
    v_lshl_add_u32 v8, v4, 2, v241
    s_waitcnt lgkmcnt(0)
    s_barrier
L_clip:
    v_add_u32 v10, v4, v3
    v_min_i32 v10, 224, v10
    v_sub_u32 v10, v10, v4
    v_add_u32 v10, v10, v240
L_masks:
    v_cmp_lt_i32 s[64:65], 0, v10
    v_cmp_lt_i32 s[66:67], 2, v10
    v_cmp_lt_i32 s[68:69], 4, v10
    v_cmp_lt_i32 s[70:71], 6, v10
    v_cmp_lt_i32 s[72:73], 8, v10
    v_cmp_lt_i32 s[74:75], 10, v10
    v_cmp_lt_i32 s[76:77], 12, v10
    v_cmp_lt_i32 s[78:79], 14, v10
    s_nop 0
    s_branch L_mapw
L_map2:
    v_add_u32 v8, 56, v8
    v_subrev_u32 v10, 14, v10
    s_branch L_masks
L_r1:
    ds_read_b32 v139, v242 offset:768
    ds_read_b32 v146, v243 offset:768
    s_waitcnt lgkmcnt(0)
    v_mad_u32_u24 v139, v139, 12, v244
    buffer_load_dwordx3 v[160:162], v139, s[24:27], 0 offen offset:2304 sc1
    v_lshl_add_u32 v146, v146, 5, v2
    s_add_u32 m0, s52, 4096
    s_nop 0
    buffer_load_dwordx4 v146, s[28:31], s98 offen offset:2048 sc1 lds
    s_branch L_r1b
L_r2:
    v_lshrrev_b32 v135, 21, v162
    v_lshlrev_b32 v135, 2, v135
    v_lshrrev_b32 v11, 26, v162
    v_lshl_or_b32 v11, v11, 4, v245
    s_mov_b64 exec, s[96:97]
    ds_add_rtn_u32 v131, v135, v6 offset:8192
    ds_add_u32 v11, v6 offset:14336
    s_mov_b64 exec, -1
    s_mov_b32 exec_hi, 0
    ds_write_b64 v246, v[160:161] offset:1536
    s_mov_b32 exec_hi, -1
    v_and_or_b32 v162, v162, s55, v247
    v_add_u32 v162, 402653184, v162
    s_branch L_r2b
L_r3:
    ds_read_b32 v135, v135 offset:8192
    s_waitcnt lgkmcnt(0)
    v_bfe_u32 v15, v135, 12, 3
    v_or_b32 v162, v15, v162
    v_and_b32 v139, 0x3ff, v135
    v_lshrrev_b32 v135, 16, v135
    v_add_u32 v135, v135, v131
    ds_read_b32 v139, v139 offset:16384
    s_waitcnt lgkmcnt(0)
    v_lshl_add_u32 v135, v135, 2, v139
    s_mov_b64 exec, s[96:97]
    ds_write_b32 v135, v162
    s_mov_b64 exec, -1
    s_branch L_r3b
L_tag:
    v_mov_b32 v11, s62
    s_mov_b32 s54, 786432
    buffer_store_dword v11, v242, s[20:23], s54 offen sc1
    s_branch L_tagged
L_empty:
    s_waitcnt vmcnt(0) lgkmcnt(0)
    s_barrier
    v_lshlrev_b32 v12, 2, v1
    s_lshl_b32 s61, s3, 7
    v_and_b32 v205, 0x7380, v205
    v_xor_b32 v205, s61, v205
    v_alignbit_b32 v205, v205, v205, 12
    v_cmp_eq_u32 s[80:81], 0, v205
    v_cmp_eq_u32 s[82:83], 1, v205
    v_cmp_eq_u32 s[84:85], 2, v205
    v_cmp_eq_u32 s[96:97], 3, v205
    v_cmp_eq_u32 vcc, 4, v205
    s_ff1_i32_b64 s56, s[80:81]
    s_mul_i32 s56, s56, 1152
    v_add_u32 v208, s56, v12
    s_ff1_i32_b64 s57, s[82:83]
    s_mul_i32 s57, s57, 1152
    v_add_u32 v209, s57, v12
    s_ff1_i32_b64 s58, s[84:85]
    s_mul_i32 s58, s58, 1152
    v_add_u32 v210, s58, v12
    s_ff1_i32_b64 s59, s[96:97]
    s_mul_i32 s59, s59, 1152
    v_add_u32 v211, s59, v12
    s_ff1_i32_b64 s60, vcc
    s_mul_i32 s60, s60, 1152
    v_add_u32 v212, s60, v12
    ds_read_b128 v[96:99], v215 offset:6144
    ds_read_b128 v[100:103], v215 offset:7168
    ds_read_b128 v[104:107], v215 offset:8192
    ds_read_b128 v[108:111], v215 offset:9216
    ds_read_b128 v[112:115], v215 offset:10240
    ds_read_b128 v[116:119], v215 offset:11264
    ds_read_b128 v[120:123], v215 offset:12288
    ds_read_b128 v[124:127], v215 offset:13312
    ds_read_b128 v[144:147], v215 offset:14336
    ds_read_b128 v[148:151], v215 offset:15360
    s_branch L_swept
L_two:
    s_nop 7
    v_cvt_pk_bf16_f32 v72, v176, v180
    v_cvt_pk_bf16_f32 v80, v176, v180
    v_cvt_pk_bf16_f32 v74, v178, v182
    v_cvt_pk_bf16_f32 v73, v184, v188
    v_cvt_pk_bf16_f32 v81, v184, v188
    v_cvt_pk_bf16_f32 v75, v186, v190
    v_mov_b32_dpp v72, v74 row_ror:8 row_mask:0xf bank_mask:0xc
    s_nop 0
    v_mov_b32_dpp v73, v75 row_ror:8 row_mask:0xf bank_mask:0xc
    v_mov_b32_dpp v74, v80 row_ror:8 row_mask:0xf bank_mask:0x3
    v_mov_b32_dpp v75, v81 row_ror:8 row_mask:0xf bank_mask:0x3
    buffer_store_dwordx4 v[72:75], v214, s[40:43], s87 offen offset:0 sc1
    v_cvt_pk_bf16_f32 v76, v177, v181
    v_cvt_pk_bf16_f32 v82, v177, v181
    v_cvt_pk_bf16_f32 v78, v179, v183
    v_cvt_pk_bf16_f32 v77, v185, v189
    v_cvt_pk_bf16_f32 v83, v185, v189
    v_cvt_pk_bf16_f32 v79, v187, v191
    v_mov_b32_dpp v76, v78 row_ror:8 row_mask:0xf bank_mask:0xc
    s_nop 0
    v_mov_b32_dpp v77, v79 row_ror:8 row_mask:0xf bank_mask:0xc
    v_mov_b32_dpp v78, v82 row_ror:8 row_mask:0xf bank_mask:0x3
    v_mov_b32_dpp v79, v83 row_ror:8 row_mask:0xf bank_mask:0x3
    buffer_store_dwordx4 v[76:79], v214, s[40:43], s87 offen offset:256 sc1
    s_add_u32 s87, s87, 4096
    s_branch L_stored
L_poll:
    buffer_load_dwordx2 v[206:207], v10, s[20:23], s49 offen sc1
    s_sub_u32 s53, s53, 1
    s_cbranch_scc1 L_done
    s_waitcnt vmcnt(0)
    v_xor_b32 v11, s63, v206
    v_xor_b32 v12, s62, v207
    v_and_or_b32 v11, v11, s55, v12
    v_cmpx_ne_u32 vcc, 0, v11
    s_cbranch_execnz L_poll
    s_branch L_polled
L_rank2:
    ds_read_b32 v96, v248 offset:8192
    ds_read_b32 v97, v248 offset:8320
    ds_read_b32 v98, v248 offset:8448
    ds_read_b32 v99, v248 offset:8576
    ds_read_b32 v100, v248 offset:8704
    ds_write_b64 v246, v[148:149] offset:0
    v_and_or_b32 v150, v150, s55, v247
    ds_write_b64 v246, v[152:153] offset:512
    v_and_or_b32 v154, v154, s55, v247
    v_add_u32 v154, 134217728, v154
    ds_write_b64 v246, v[156:157] offset:1024
    v_and_or_b32 v158, v158, s55, v247
    v_add_u32 v158, 268435456, v158
    s_waitcnt lgkmcnt(0)
L_end:
    s_branch L_ranked
.section .rodata,"a"
.p2align 6
.amdhsa_kernel gather_scatter__tensor_product_equiv_mace__graph_kernel
  .amdhsa_next_free_vgpr 256
  .amdhsa_next_free_sgpr 102
  .amdhsa_accum_offset 256
  .amdhsa_group_segment_fixed_size 0
  .amdhsa_kernarg_size 88
  .amdhsa_user_sgpr_count 2
  .amdhsa_user_sgpr_kernarg_segment_ptr 1
  .amdhsa_system_sgpr_workgroup_id_x 1
  .amdhsa_float_denorm_mode_32 3
.end_amdhsa_kernel
```
